```python
import torch

def _softmax(x, axis=-1):
    return torch.softmax(x, dim=axis)
def _gelu(x):
    return torch.nn.functional.gelu(x, approximate="tanh")
def _silu(x):
    return torch.nn.functional.silu(x)
def _sigmoid(x):
    return torch.sigmoid(x)
def _layernorm(x, axis=-1, eps=1e-5):
    m = x.mean(dim=axis, keepdim=True)
    v = x.var(dim=axis, keepdim=True, unbiased=False)
    return (x - m) / torch.sqrt(v + eps)
def _scatter_add(tgt, idx, src, axis=0):
    return tgt.clone().index_add_(axis, idx, src)
def _segment_sum(src, seg, n):
    out = torch.zeros((n,) + src.shape[1:], dtype=src.dtype)
    return out.index_add_(0, seg, src)
def _pad(x, pw):
    flat = tuple(v for pair in reversed(pw) for v in pair)
    return torch.nn.functional.pad(x, flat)

kernel_name = 'parallel_sum__softmax_full_mha__dense_activation_squared_relu__prompt'

def setup_inputs():

    _w = (lambda a: (lambda t: t.to(torch.bfloat16) if t.is_floating_point() else t)(torch.as_tensor(a)))
    def _A_setup():
        B, S, D = 1, 2048, 640
        return {
            "x": _w((lambda *s: torch.randn(*s, dtype=torch.bfloat16) * 0.05)(B, S, D)),
            "wqkv": _w((lambda *s: torch.randn(*s, dtype=torch.bfloat16) * 0.2)(D, 3 * D)),
            "wo": _w((lambda *s: torch.randn(*s, dtype=torch.bfloat16) * 0.1)(D, D)),
        }
    _A_in = _A_setup()

    def _B_setup():
        B, S, D, F = 1, 2048, 640, 1536
        return {
            "x": _w((lambda *s: torch.randn(*s, dtype=torch.bfloat16) * 0.05)(B, S, D)),
            "w1": _w((lambda *s: torch.randn(*s, dtype=torch.bfloat16) * 0.1)(D, F)),
            "b1": _w((lambda *s: torch.randn(*s, dtype=torch.bfloat16) * 0.1)(F)),
            "w2": _w((lambda *s: torch.randn(*s, dtype=torch.bfloat16) * 0.1)(F, D)),
            "b2": _w((lambda *s: torch.randn(*s, dtype=torch.bfloat16) * 0.1)(D)),
        }
    _B_in = _B_setup()

    return {
        "A_x": _A_in["x"],
        "A_wqkv": _A_in["wqkv"],
        "A_wo": _A_in["wo"],
        "B_x": _B_in["x"],
        "B_w1": _B_in["w1"],
        "B_b1": _B_in["b1"],
        "B_w2": _B_in["w2"],
        "B_b2": _B_in["b2"],
    }

def reference(A_x, A_wqkv, A_wo, B_x, B_w1, B_b1, B_w2, B_b2):
    def _A_ref(x, wqkv, wo):
        B, S, D = x.shape
        H = 32; Dh = D // H
        qkv = (lambda x, *d: x.permute(*d))((x @ wqkv).reshape(B, S, 3, H, Dh), 2, 0, 3, 1, 4)
        q, k, v = qkv[0], qkv[1], qkv[2]
        scale = Dh ** -0.5
        scores = torch.einsum("bhqd,bhkd->bhqk", q, k) * scale
        p = _softmax(scores, axis=-1)
        o = torch.einsum("bhqk,bhkd->bhqd", p, v)
        return (lambda x, *d: x.permute(*d))(o, 0, 2, 1, 3).reshape(B, S, D) @ wo

    def _B_ref(x, w1, b1, w2, b2):
        h = torch.einsum("bsd,df->bsf", x, w1) + b1
        zero = torch.zeros_like(h)
        r = torch.where(h > zero, h, zero)
        h = r * r
        out = torch.einsum("bsf,fd->bsd", h, w2) + b2
        return out

    x = A_x
    xn = _layernorm(x, axis=-1)
    return x + _A_ref(xn, A_wqkv, A_wo) + _B_ref(xn, B_w1, B_b1, B_w2, B_b2)
```

```asm
; @launch kernel=k1_kernel grid=(256,1,1) block=(768,1,1) lds=154112
; @launch kernel=k2_kernel grid=(256,1,1) block=(768,1,1) lds=163840
.amdgcn_target "amdgcn-amd-amdhsa--gfx950"
.text
.globl k1_kernel
.p2align 8
.type k1_kernel,@function
k1_kernel:
    s_cmp_ge_u32 s2, 256
    s_cbranch_scc1 K1_END
    s_load_dwordx4 s[4:7], s[0:1], 0
    s_load_dwordx4 s[64:67], s[0:1], 32
    s_load_dwordx2 s[20:21], s[0:1], 80
    s_load_dwordx2 s[60:61], s[0:1], 16
    s_load_dwordx2 s[62:63], s[0:1], 48
    v_and_b32 v1, 63, v0
    v_lshrrev_b32 v9, 6, v0
    v_and_b32 v2, 31, v1
    v_readfirstlane_b32 s30, v9
    v_lshrrev_b32 v3, 5, v1
    v_lshlrev_b32 v4, 4, v1
    s_and_b32 s58, s2, 7
    s_lshr_b32 s59, s2, 3
    s_and_b32 s28, s58, 1
    s_lshl_b32 s28, s28, 3
    s_and_b32 s29, s59, 7
    s_add_u32 s28, s28, s29
    s_lshr_b32 s29, s58, 1
    s_lshr_b32 s57, s29, 1
    s_xor_b32 s29, s29, s57
    s_lshl_b32 s29, s29, 2
    s_lshr_b32 s59, s59, 3
    s_add_u32 s29, s29, s59
    s_and_b32 s31, s30, 3
    s_lshl_b32 s55, s28, 2
    s_add_u32 s55, s55, s31
    s_cmp_ge_u32 s29, 12
    s_cbranch_scc1 K1_COLB
    s_mul_i32 s58, s29, 320
    s_mov_b32 s48, s58
    s_add_u32 s49, s58, 64
    s_add_u32 s50, s58, 128
    s_add_u32 s51, s58, 192
    s_add_u32 s52, s58, 256
    s_lshl_b32 s58, s29, 7
    s_mov_b32 s53, s58
    s_add_u32 s54, s58, 64
    s_branch K1_COLD
K1_COLB:
    s_sub_u32 s58, s29, 12
    s_mul_i32 s58, s58, 384
    s_add_u32 s58, s58, 1536
    s_mov_b32 s48, s58
    s_add_u32 s49, s58, 64
    s_add_u32 s50, s58, 128
    s_mov_b32 s51, 0
    s_add_u32 s52, s58, 192
    s_add_u32 s53, s58, 256
    s_add_u32 s54, s58, 320
K1_COLD:
    s_mov_b32 s32, 0
    s_cmp_ge_u32 s30, 8
    s_cbranch_scc1 K1_LOADER
    s_cmp_ge_u32 s2, 8
    s_cbranch_scc1 K1_NOPF
    s_cmp_lg_u32 s30, 0
    s_cbranch_scc1 K1_NOPF
    s_getpc_b64 s[58:59]
PF_PC_k1:
    s_add_u32 s58, s58, (k1_kernel-PF_PC_k1)&0xffffffff
    s_addc_u32 s59, s59, ((k1_kernel-PF_PC_k1)>>32)&0xffffffff
    v_mbcnt_lo_u32_b32 v5, -1, 0
    v_mbcnt_hi_u32_b32 v5, -1, v5
    v_lshlrev_b32 v5, 7, v5
    v_min_u32 v160, K2_TEXT_END-k1_kernel-4, v5
    global_load_dword v160, v160, s[58:59]
    v_add_u32 v5, 8192, v5
    v_min_u32 v161, K2_TEXT_END-k1_kernel-4, v5
    global_load_dword v161, v161, s[58:59]
    v_add_u32 v5, 8192, v5
    v_min_u32 v162, K2_TEXT_END-k1_kernel-4, v5
    global_load_dword v162, v162, s[58:59]
    v_add_u32 v5, 8192, v5
    v_min_u32 v163, K2_TEXT_END-k1_kernel-4, v5
    global_load_dword v163, v163, s[58:59]
    v_add_u32 v5, 8192, v5
    v_min_u32 v164, K2_TEXT_END-k1_kernel-4, v5
    global_load_dword v164, v164, s[58:59]
K1_NOPF:
    s_setprio 1
    v_lshrrev_b32 v9, 1, v2
    v_and_b32 v9, 7, v9
    s_lshl_b32 s58, s31, 12
    v_lshlrev_b32 v5, 7, v2
    v_add_u32 v5, s58, v5
    v_add_u32 v6, 0, v3
    v_xor_b32 v6, v6, v9
    v_lshl_add_u32 v10, v6, 4, v5
    v_add_u32 v6, 2, v3
    v_xor_b32 v6, v6, v9
    v_lshl_add_u32 v11, v6, 4, v5
    v_add_u32 v6, 4, v3
    v_xor_b32 v6, v6, v9
    v_lshl_add_u32 v12, v6, 4, v5
    v_add_u32 v6, 6, v3
    v_xor_b32 v6, v6, v9
    v_lshl_add_u32 v13, v6, 4, v5
    v_lshrrev_b32 v9, 5, v1
    v_lshlrev_b32 v9, 9, v9
    v_bfe_u32 v5, v1, 2, 2
    v_lshl_add_u32 v9, v5, 6, v9
    v_bfe_u32 v5, v1, 4, 1
    v_lshl_add_u32 v9, v5, 5, v9
    v_and_b32 v6, 3, v1
    v_lshl_add_u32 v9, v6, 3, v9
    v_add_u32 v14, 16384, v9
    s_cmp_ge_u32 s29, 12
    s_cbranch_scc1 K1_OLDW
    v_lshrrev_b32 v7, 5, v1
    v_bfe_u32 v8, v1, 2, 2
    v_lshl_add_u32 v7, v7, 3, v8
    v_lshlrev_b32 v8, 5, v5
    v_lshl_add_u32 v8, v6, 3, v8
    v_mul_u32_u24 v14, 320, v7
    v_add_u32 v14, v14, v8
    v_add_u32 v14, 16384, v14
    v_lshl_add_u32 v19, v7, 7, v8
    v_add_u32 v19, 36864, v19
    v_bfe_u32 v7, v1, 3, 1
    v_lshlrev_b32 v7, 6, v7
    v_xor_b32 v8, 64, v7
    v_add_u32 v9, v19, v8
    v_add_u32 v19, v19, v7
K1_OLDW:
    v_and_b32 v6, 1, v1
    v_cmp_eq_u32 vcc, v5, v6
    v_mov_b32 v6, 0x3f803f80
    s_nop 0
    v_cndmask_b32 v20, 0, v6, vcc
    v_mov_b32 v21, v20
    v_mov_b32 v22, v20
    v_mov_b32 v23, v20
    s_mov_b32 s35, 0
    v_mov_b32 v15, 0
    v_mov_b32 v16, 0
    v_mov_b32 v17, 0
    v_mov_b32 v18, 0
    v_mov_b32 v64, 0
    v_mov_b32 v65, 0
    v_mov_b32 v66, 0
    v_mov_b32 v67, 0
    v_mov_b32 v68, 0
    v_mov_b32 v69, 0
    v_mov_b32 v70, 0
    v_mov_b32 v71, 0
    v_mov_b32 v72, 0
    v_mov_b32 v73, 0
    v_mov_b32 v74, 0
    v_mov_b32 v75, 0
    v_mov_b32 v76, 0
    v_mov_b32 v77, 0
    v_mov_b32 v78, 0
    v_mov_b32 v79, 0
    v_mov_b32 v80, 0
    v_mov_b32 v81, 0
    v_mov_b32 v82, 0
    v_mov_b32 v83, 0
    v_mov_b32 v84, 0
    v_mov_b32 v85, 0
    v_mov_b32 v86, 0
    v_mov_b32 v87, 0
    v_mov_b32 v88, 0
    v_mov_b32 v89, 0
    v_mov_b32 v90, 0
    v_mov_b32 v91, 0
    v_mov_b32 v92, 0
    v_mov_b32 v93, 0
    v_mov_b32 v94, 0
    v_mov_b32 v95, 0
    v_mov_b32 v96, 0
    v_mov_b32 v97, 0
    v_mov_b32 v98, 0
    v_mov_b32 v99, 0
    v_mov_b32 v100, 0
    v_mov_b32 v101, 0
    v_mov_b32 v102, 0
    v_mov_b32 v103, 0
    v_mov_b32 v104, 0
    v_mov_b32 v105, 0
    v_mov_b32 v106, 0
    v_mov_b32 v107, 0
    v_mov_b32 v108, 0
    v_mov_b32 v109, 0
    v_mov_b32 v110, 0
    v_mov_b32 v111, 0
    v_mov_b32 v112, 0
    v_mov_b32 v113, 0
    v_mov_b32 v114, 0
    v_mov_b32 v115, 0
    v_mov_b32 v116, 0
    v_mov_b32 v117, 0
    v_mov_b32 v118, 0
    v_mov_b32 v119, 0
    v_mov_b32 v120, 0
    v_mov_b32 v121, 0
    v_mov_b32 v122, 0
    v_mov_b32 v123, 0
    v_mov_b32 v124, 0
    v_mov_b32 v125, 0
    v_mov_b32 v126, 0
    v_mov_b32 v127, 0
    v_mov_b32 v128, 0
    v_mov_b32 v129, 0
    v_mov_b32 v130, 0
    v_mov_b32 v131, 0
    v_mov_b32 v132, 0
    v_mov_b32 v133, 0
    v_mov_b32 v134, 0
    v_mov_b32 v135, 0
    v_mov_b32 v136, 0
    v_mov_b32 v137, 0
    v_mov_b32 v138, 0
    v_mov_b32 v139, 0
    v_mov_b32 v140, 0
    v_mov_b32 v141, 0
    v_mov_b32 v142, 0
    v_mov_b32 v143, 0
    v_mov_b32 v44, 0
    v_mov_b32 v45, 0
    v_mov_b32 v46, 0
    v_mov_b32 v47, 0
    v_mov_b32 v48, 0
    v_mov_b32 v49, 0
    v_mov_b32 v50, 0
    v_mov_b32 v51, 0
    v_mov_b32 v52, 0
    v_mov_b32 v53, 0
    v_mov_b32 v54, 0
    v_mov_b32 v55, 0
    v_mov_b32 v56, 0
    v_mov_b32 v57, 0
    v_mov_b32 v58, 0
    v_mov_b32 v59, 0
    v_mov_b32 v60, 0
    v_mov_b32 v61, 0
    v_mov_b32 v62, 0
    v_mov_b32 v63, 0
    s_waitcnt lgkmcnt(0)
    s_cmp_ge_u32 s30, 4
    s_cbranch_scc1 K1_CH1
    s_cmp_ge_u32 s29, 12
    s_cbranch_scc1 K1_CH0B
K1_CH0A:
.p2align 6
.p2align 6
K1_LOOP_CH0A:
    s_barrier
    v_mfma_f32_32x32x16_bf16 v[64:79], v[48:51], v[44:47], v[64:79]
    ds_read_b128 v[24:27], v10
    ds_read_b64_tr_b16 v[28:29], v14 offset:0
    ds_read_b64_tr_b16 v[30:31], v14 offset:1280
    v_mfma_f32_32x32x16_bf16 v[80:95], v[52:55], v[44:47], v[80:95]
    ds_read_b64_tr_b16 v[32:33], v14 offset:64
    ds_read_b64_tr_b16 v[34:35], v14 offset:1344
    ds_read_b64_tr_b16 v[36:37], v14 offset:128
    v_mfma_f32_32x32x16_bf16 v[96:111], v[56:59], v[44:47], v[96:111]
    ds_read_b64_tr_b16 v[38:39], v14 offset:1408
    ds_read_b64_tr_b16 v[40:41], v14 offset:192
    ds_read_b64_tr_b16 v[42:43], v14 offset:1472
    v_mfma_f32_32x32x16_bf16 v[112:127], v[60:63], v[44:47], v[112:127]
    s_cmp_eq_u32 s31, 0
    s_cbranch_scc1 K1_CS_CH0A_a
K1_CSR_CH0A_a:
    s_waitcnt lgkmcnt(6)
    v_mfma_f32_32x32x16_bf16 v[64:79], v[28:31], v[24:27], v[64:79]
    ds_read_b128 v[44:47], v11
    ds_read_b64_tr_b16 v[48:49], v14 offset:5120
    ds_read_b64_tr_b16 v[50:51], v14 offset:6400
    s_waitcnt lgkmcnt(7)
    v_mfma_f32_32x32x16_bf16 v[80:95], v[32:35], v[24:27], v[80:95]
    ds_read_b64_tr_b16 v[52:53], v14 offset:5184
    ds_read_b64_tr_b16 v[54:55], v14 offset:6464
    ds_read_b64_tr_b16 v[56:57], v14 offset:5248
    s_waitcnt lgkmcnt(8)
    v_mfma_f32_32x32x16_bf16 v[96:111], v[36:39], v[24:27], v[96:111]
    ds_read_b64_tr_b16 v[58:59], v14 offset:6528
    ds_read_b64_tr_b16 v[60:61], v14 offset:5312
    ds_read_b64_tr_b16 v[62:63], v14 offset:6592
    s_waitcnt lgkmcnt(9)
    v_mfma_f32_32x32x16_bf16 v[112:127], v[40:43], v[24:27], v[112:127]
    s_cmp_eq_u32 s31, 1
    s_cbranch_scc1 K1_CS_CH0A_b
K1_CSR_CH0A_b:
    s_waitcnt lgkmcnt(6)
    v_mfma_f32_32x32x16_bf16 v[64:79], v[48:51], v[44:47], v[64:79]
    ds_read_b128 v[24:27], v12
    ds_read_b64_tr_b16 v[28:29], v14 offset:10240
    ds_read_b64_tr_b16 v[30:31], v14 offset:11520
    s_waitcnt lgkmcnt(7)
    v_mfma_f32_32x32x16_bf16 v[80:95], v[52:55], v[44:47], v[80:95]
    ds_read_b64_tr_b16 v[32:33], v14 offset:10304
    ds_read_b64_tr_b16 v[34:35], v14 offset:11584
    ds_read_b64_tr_b16 v[36:37], v14 offset:10368
    s_waitcnt lgkmcnt(8)
    v_mfma_f32_32x32x16_bf16 v[96:111], v[56:59], v[44:47], v[96:111]
    ds_read_b64_tr_b16 v[38:39], v14 offset:11648
    ds_read_b64_tr_b16 v[40:41], v14 offset:10432
    ds_read_b64_tr_b16 v[42:43], v14 offset:11712
    s_waitcnt lgkmcnt(9)
    v_mfma_f32_32x32x16_bf16 v[112:127], v[60:63], v[44:47], v[112:127]
    s_cmp_eq_u32 s31, 2
    s_cbranch_scc1 K1_CS_CH0A_c
K1_CSR_CH0A_c:
    s_waitcnt lgkmcnt(6)
    v_mfma_f32_32x32x16_bf16 v[64:79], v[28:31], v[24:27], v[64:79]
    ds_read_b128 v[44:47], v13
    ds_read_b64_tr_b16 v[48:49], v14 offset:15360
    ds_read_b64_tr_b16 v[50:51], v14 offset:16640
    ds_read_b64_tr_b16 v[52:53], v14 offset:15424
    ds_read_b64_tr_b16 v[54:55], v14 offset:16704
    s_waitcnt lgkmcnt(9)
    v_mfma_f32_32x32x16_bf16 v[80:95], v[32:35], v[24:27], v[80:95]
    ds_read_b64_tr_b16 v[56:57], v14 offset:15488
    ds_read_b64_tr_b16 v[58:59], v14 offset:16768
    ds_read_b64_tr_b16 v[60:61], v14 offset:15552
    ds_read_b64_tr_b16 v[62:63], v14 offset:16832
    s_waitcnt lgkmcnt(11)
    v_mfma_f32_32x32x16_bf16 v[96:111], v[36:39], v[24:27], v[96:111]
    s_waitcnt lgkmcnt(9)
    v_mfma_f32_32x32x16_bf16 v[112:127], v[40:43], v[24:27], v[112:127]
    s_cmp_eq_u32 s31, 3
    s_cbranch_scc1 K1_CS_CH0A_d
K1_CSR_CH0A_d:
    s_add_u32 s35, s35, 1
    s_cmp_eq_u32 s35, 3
    s_mov_b32 s34, 45056
    s_cselect_b32 s34, 4294877184, s34
    s_cselect_b32 s35, 0, s35
    v_add_u32 v10, s34, v10
    v_add_u32 v11, s34, v11
    v_add_u32 v12, s34, v12
    v_add_u32 v13, s34, v13
    v_add_u32 v14, s34, v14
    s_add_u32 s32, s32, 1
    s_cmp_lt_u32 s32, 10
    s_waitcnt lgkmcnt(0)
    s_cbranch_scc1 K1_LOOP_CH0A
    v_mfma_f32_32x32x16_bf16 v[64:79], v[48:51], v[44:47], v[64:79]
    v_mfma_f32_32x32x16_bf16 v[80:95], v[52:55], v[44:47], v[80:95]
    v_mfma_f32_32x32x16_bf16 v[96:111], v[56:59], v[44:47], v[96:111]
    v_mfma_f32_32x32x16_bf16 v[112:127], v[60:63], v[44:47], v[112:127]
    s_cmp_eq_u32 s31, 0
    s_cbranch_scc1 K1_CS_CH0A_e
K1_CSR_CH0A_e:
    v_lshlrev_b32 v144, 4, v1
    s_lshl_b32 s58, s31, 2
    s_add_u32 s58, s58, 137216
    v_add_u32 v144, s58, v144
    s_nop 6
    s_mov_b64 exec, 0xffff
    ds_write_b32 v144, v128 offset:0
    ds_write_b32 v144, v129 offset:256
    ds_write_b32 v144, v132 offset:512
    ds_write_b32 v144, v133 offset:768
    ds_write_b32 v144, v136 offset:1024
    ds_write_b32 v144, v137 offset:1280
    ds_write_b32 v144, v140 offset:1536
    ds_write_b32 v144, v141 offset:1792
    s_mov_b64 exec, -1
    s_and_b32 s21, s21, 0xffff
    s_mov_b32 s22, 33554432
    s_mov_b32 s23, 0x00020000
    s_waitcnt lgkmcnt(0)
    s_barrier
    s_lshl_b32 s58, s31, 8
    s_add_u32 s58, s58, 135168
    v_lshl_add_u32 v144, v2, 3, s58
    ds_read_b64 v[148:149], v144
    ds_read_b64 v[150:151], v144 offset:1024
    v_lshlrev_b32 v145, 4, v2
    v_add_u32 v145, 137216, v145
    v_lshlrev_b32 v146, 2, v2
    v_add_u32 v146, 140800, v146
    ds_read_b128 v[44:47], v145 offset:0
    v_mov_b32 v36, 0
    ds_read_b128 v[48:51], v145 offset:512
    v_mov_b32 v37, 0
    ds_read_b128 v[52:55], v145 offset:1024
    v_mov_b32 v38, 0
    ds_read_b128 v[56:59], v145 offset:1536
    v_mov_b32 v39, 0
    v_cmp_eq_u32 vcc, 1, v3
    s_waitcnt lgkmcnt(0)
    v_add_f32 v15, v148, v150
    v_add_f32 v16, v149, v151
    v_mul_f32 v15, 0xbacccccd, v15
    v_mul_f32 v16, 0x3acccccd, v16
    v_fma_f32 v16, -v15, v15, v16
    v_max_f32 v16, 0, v16
    v_add_f32 v16, 0x3727c5ac, v16
    v_rsq_f32 v17, v16
    s_nop 0
    v_mul_f32 v16, v16, v17
    v_cvt_pk_bf16_f32 v24, v15, v15
    v_and_b32 v144, 0xffff0000, v24
    v_sub_f32 v144, v15, v144
    v_cvt_pk_bf16_f32 v25, v144, v16
    v_and_b32 v144, 0xffff0000, v25
    v_sub_f32 v144, v16, v144
    v_cvt_pk_bf16_f32 v144, v144, 0
    v_cndmask_b32 v24, v24, v144, vcc
    v_cndmask_b32_e64 v25, v25, 0, vcc
    v_add_f32 v44, v44, v45
    v_add_f32 v46, v46, v47
    v_add_f32 v44, v44, v46
    v_cvt_pk_bf16_f32 v45, v44, v44
    v_and_b32 v46, 0xffff0000, v45
    v_sub_f32 v46, v44, v46
    v_cvt_pk_bf16_f32 v28, v44, v46
    v_and_b32 v45, 0xffff, v45
    v_lshl_or_b32 v29, v36, 16, v45
    v_cndmask_b32 v28, v28, v36, vcc
    v_cndmask_b32_e64 v29, v29, 0, vcc
    v_add_f32 v48, v48, v49
    v_add_f32 v50, v50, v51
    v_add_f32 v48, v48, v50
    v_cvt_pk_bf16_f32 v49, v48, v48
    v_and_b32 v50, 0xffff0000, v49
    v_sub_f32 v50, v48, v50
    v_cvt_pk_bf16_f32 v30, v48, v50
    v_and_b32 v49, 0xffff, v49
    v_lshl_or_b32 v31, v37, 16, v49
    v_cndmask_b32 v30, v30, v37, vcc
    v_cndmask_b32_e64 v31, v31, 0, vcc
    v_add_f32 v52, v52, v53
    v_add_f32 v54, v54, v55
    v_add_f32 v52, v52, v54
    v_cvt_pk_bf16_f32 v53, v52, v52
    v_and_b32 v54, 0xffff0000, v53
    v_sub_f32 v54, v52, v54
    v_cvt_pk_bf16_f32 v32, v52, v54
    v_and_b32 v53, 0xffff, v53
    v_lshl_or_b32 v33, v38, 16, v53
    v_cndmask_b32 v32, v32, v38, vcc
    v_cndmask_b32_e64 v33, v33, 0, vcc
    v_add_f32 v56, v56, v57
    v_add_f32 v58, v58, v59
    v_add_f32 v56, v56, v58
    v_cvt_pk_bf16_f32 v57, v56, v56
    v_and_b32 v58, 0xffff0000, v57
    v_sub_f32 v58, v56, v58
    v_cvt_pk_bf16_f32 v34, v56, v58
    v_and_b32 v57, 0xffff, v57
    v_lshl_or_b32 v35, v39, 16, v57
    v_cndmask_b32 v34, v34, v39, vcc
    v_cndmask_b32_e64 v35, v35, 0, vcc
    s_nop 1
    v_mfma_f32_32x32x8_bf16 v[64:79], v[28:29], v[24:25], v[64:79]
    v_mfma_f32_32x32x8_bf16 v[80:95], v[30:31], v[24:25], v[80:95]
    v_mfma_f32_32x32x8_bf16 v[96:111], v[32:33], v[24:25], v[96:111]
    v_mfma_f32_32x32x8_bf16 v[112:127], v[34:35], v[24:25], v[112:127]
    s_lshl_b32 s58, s31, 5
    v_add_u32 v9, s58, v2
    v_mul_u32_u24 v6, 40, v9
    v_mul_u32_u24 v8, 328, v9
    v_mul_u32_u24 v9, 5088, v3
    v_add_u32 v7, v6, v9
    v_lshl_add_u32 v6, v3, 3, v6
    v_lshl_add_u32 v8, v3, 3, v8
    s_cmp_lt_u32 s29, 4
    s_cselect_b32 s60, 0x3ea52b5c, 1.0
    v_mul_f32 v152, s60, v17
    s_nop 7
    s_nop 3
    v_pk_mul_f32 v[64:65], v[64:65], v[152:153] op_sel_hi:[1,0]
    v_pk_mul_f32 v[66:67], v[66:67], v[152:153] op_sel_hi:[1,0]
    v_pk_mul_f32 v[68:69], v[68:69], v[152:153] op_sel_hi:[1,0]
    v_pk_mul_f32 v[70:71], v[70:71], v[152:153] op_sel_hi:[1,0]
    v_pk_mul_f32 v[72:73], v[72:73], v[152:153] op_sel_hi:[1,0]
    v_pk_mul_f32 v[74:75], v[74:75], v[152:153] op_sel_hi:[1,0]
    v_pk_mul_f32 v[76:77], v[76:77], v[152:153] op_sel_hi:[1,0]
    v_pk_mul_f32 v[78:79], v[78:79], v[152:153] op_sel_hi:[1,0]
    v_cvt_pk_bf16_f32 v144, v64, v65
    v_cvt_pk_bf16_f32 v145, v66, v67
    v_cvt_pk_bf16_f32 v146, v68, v69
    v_cvt_pk_bf16_f32 v147, v70, v71
    v_cvt_pk_bf16_f32 v148, v72, v73
    v_cvt_pk_bf16_f32 v149, v74, v75
    v_cvt_pk_bf16_f32 v150, v76, v77
    v_cvt_pk_bf16_f32 v151, v78, v79
    s_cmp_ge_u32 s29, 8
    s_cbranch_scc1 K1_SV_CH0A_0
    ds_write_b64 v6, v[144:145] offset:0
    ds_write_b64 v6, v[146:147] offset:16
    ds_write_b64 v7, v[148:149] offset:32
    ds_write_b64 v6, v[150:151] offset:5128
    s_branch K1_SE_CH0A_0
K1_SV_CH0A_0:
    ds_write_b64 v8, v[144:145] offset:0
    ds_write_b64 v8, v[146:147] offset:16
    ds_write_b64 v8, v[148:149] offset:32
    ds_write_b64 v8, v[150:151] offset:48
K1_SE_CH0A_0:
    v_pk_mul_f32 v[80:81], v[80:81], v[152:153] op_sel_hi:[1,0]
    v_pk_mul_f32 v[82:83], v[82:83], v[152:153] op_sel_hi:[1,0]
    v_pk_mul_f32 v[84:85], v[84:85], v[152:153] op_sel_hi:[1,0]
    v_pk_mul_f32 v[86:87], v[86:87], v[152:153] op_sel_hi:[1,0]
    v_pk_mul_f32 v[88:89], v[88:89], v[152:153] op_sel_hi:[1,0]
    v_pk_mul_f32 v[90:91], v[90:91], v[152:153] op_sel_hi:[1,0]
    v_pk_mul_f32 v[92:93], v[92:93], v[152:153] op_sel_hi:[1,0]
    v_pk_mul_f32 v[94:95], v[94:95], v[152:153] op_sel_hi:[1,0]
    v_cvt_pk_bf16_f32 v144, v80, v81
    v_cvt_pk_bf16_f32 v145, v82, v83
    v_cvt_pk_bf16_f32 v146, v84, v85
    v_cvt_pk_bf16_f32 v147, v86, v87
    v_cvt_pk_bf16_f32 v148, v88, v89
    v_cvt_pk_bf16_f32 v149, v90, v91
    v_cvt_pk_bf16_f32 v150, v92, v93
    v_cvt_pk_bf16_f32 v151, v94, v95
    s_cmp_ge_u32 s29, 8
    s_cbranch_scc1 K1_SV_CH0A_1
    ds_write_b64 v6, v[144:145] offset:5144
    ds_write_b64 v6, v[146:147] offset:10240
    ds_write_b64 v6, v[148:149] offset:10256
    ds_write_b64 v7, v[150:151] offset:10272
    s_branch K1_SE_CH0A_1
K1_SV_CH0A_1:
    ds_write_b64 v8, v[144:145] offset:64
    ds_write_b64 v8, v[146:147] offset:80
    ds_write_b64 v8, v[148:149] offset:96
    ds_write_b64 v8, v[150:151] offset:112
K1_SE_CH0A_1:
    v_pk_mul_f32 v[96:97], v[96:97], v[152:153] op_sel_hi:[1,0]
    v_pk_mul_f32 v[98:99], v[98:99], v[152:153] op_sel_hi:[1,0]
    v_pk_mul_f32 v[100:101], v[100:101], v[152:153] op_sel_hi:[1,0]
    v_pk_mul_f32 v[102:103], v[102:103], v[152:153] op_sel_hi:[1,0]
    v_pk_mul_f32 v[104:105], v[104:105], v[152:153] op_sel_hi:[1,0]
    v_pk_mul_f32 v[106:107], v[106:107], v[152:153] op_sel_hi:[1,0]
    v_pk_mul_f32 v[108:109], v[108:109], v[152:153] op_sel_hi:[1,0]
    v_pk_mul_f32 v[110:111], v[110:111], v[152:153] op_sel_hi:[1,0]
    v_cvt_pk_bf16_f32 v144, v96, v97
    v_cvt_pk_bf16_f32 v145, v98, v99
    v_cvt_pk_bf16_f32 v146, v100, v101
    v_cvt_pk_bf16_f32 v147, v102, v103
    v_cvt_pk_bf16_f32 v148, v104, v105
    v_cvt_pk_bf16_f32 v149, v106, v107
    v_cvt_pk_bf16_f32 v150, v108, v109
    v_cvt_pk_bf16_f32 v151, v110, v111
    s_cmp_ge_u32 s29, 8
    s_cbranch_scc1 K1_SV_CH0A_2
    ds_write_b64 v6, v[144:145] offset:15368
    ds_write_b64 v6, v[146:147] offset:15384
    ds_write_b64 v6, v[148:149] offset:20480
    ds_write_b64 v6, v[150:151] offset:20496
    s_branch K1_SE_CH0A_2
K1_SV_CH0A_2:
    ds_write_b64 v8, v[144:145] offset:128
    ds_write_b64 v8, v[146:147] offset:144
    ds_write_b64 v8, v[148:149] offset:160
    ds_write_b64 v8, v[150:151] offset:176
K1_SE_CH0A_2:
    v_pk_mul_f32 v[112:113], v[112:113], v[152:153] op_sel_hi:[1,0]
    v_pk_mul_f32 v[114:115], v[114:115], v[152:153] op_sel_hi:[1,0]
    v_pk_mul_f32 v[116:117], v[116:117], v[152:153] op_sel_hi:[1,0]
    v_pk_mul_f32 v[118:119], v[118:119], v[152:153] op_sel_hi:[1,0]
    v_pk_mul_f32 v[120:121], v[120:121], v[152:153] op_sel_hi:[1,0]
    v_pk_mul_f32 v[122:123], v[122:123], v[152:153] op_sel_hi:[1,0]
    v_pk_mul_f32 v[124:125], v[124:125], v[152:153] op_sel_hi:[1,0]
    v_pk_mul_f32 v[126:127], v[126:127], v[152:153] op_sel_hi:[1,0]
    v_cvt_pk_bf16_f32 v144, v112, v113
    v_cvt_pk_bf16_f32 v145, v114, v115
    v_cvt_pk_bf16_f32 v146, v116, v117
    v_cvt_pk_bf16_f32 v147, v118, v119
    v_cvt_pk_bf16_f32 v148, v120, v121
    v_cvt_pk_bf16_f32 v149, v122, v123
    v_cvt_pk_bf16_f32 v150, v124, v125
    v_cvt_pk_bf16_f32 v151, v126, v127
    s_cmp_ge_u32 s29, 8
    s_cbranch_scc1 K1_SV_CH0A_3
    ds_write_b64 v7, v[144:145] offset:20512
    ds_write_b64 v6, v[146:147] offset:25608
    ds_write_b64 v6, v[148:149] offset:25624
    ds_write_b64 v6, v[150:151] offset:30720
    s_branch K1_SE_CH0A_3
K1_SV_CH0A_3:
    ds_write_b64 v8, v[144:145] offset:192
    ds_write_b64 v8, v[146:147] offset:208
    ds_write_b64 v8, v[148:149] offset:224
    ds_write_b64 v8, v[150:151] offset:240
K1_SE_CH0A_3:
    s_waitcnt lgkmcnt(0)
    s_barrier
    s_branch K1_COPYOUT
K1_CS_CH0A_a:
    v_mfma_f32_16x16x32_bf16 v[128:131], v[20:23], v[48:51], v[128:131]
    v_mfma_f32_16x16x32_bf16 v[132:135], v[20:23], v[52:55], v[132:135]
    v_mfma_f32_16x16x32_bf16 v[136:139], v[20:23], v[56:59], v[136:139]
    v_mfma_f32_16x16x32_bf16 v[140:143], v[20:23], v[60:63], v[140:143]
    s_branch K1_CSR_CH0A_a
K1_CS_CH0A_b:
    v_mfma_f32_16x16x32_bf16 v[128:131], v[20:23], v[28:31], v[128:131]
    v_mfma_f32_16x16x32_bf16 v[132:135], v[20:23], v[32:35], v[132:135]
    v_mfma_f32_16x16x32_bf16 v[136:139], v[20:23], v[36:39], v[136:139]
    v_mfma_f32_16x16x32_bf16 v[140:143], v[20:23], v[40:43], v[140:143]
    s_branch K1_CSR_CH0A_b
K1_CS_CH0A_c:
    v_mfma_f32_16x16x32_bf16 v[128:131], v[20:23], v[48:51], v[128:131]
    v_mfma_f32_16x16x32_bf16 v[132:135], v[20:23], v[52:55], v[132:135]
    v_mfma_f32_16x16x32_bf16 v[136:139], v[20:23], v[56:59], v[136:139]
    v_mfma_f32_16x16x32_bf16 v[140:143], v[20:23], v[60:63], v[140:143]
    s_branch K1_CSR_CH0A_c
K1_CS_CH0A_d:
    v_mfma_f32_16x16x32_bf16 v[128:131], v[20:23], v[28:31], v[128:131]
    v_mfma_f32_16x16x32_bf16 v[132:135], v[20:23], v[32:35], v[132:135]
    v_mfma_f32_16x16x32_bf16 v[136:139], v[20:23], v[36:39], v[136:139]
    v_mfma_f32_16x16x32_bf16 v[140:143], v[20:23], v[40:43], v[140:143]
    s_branch K1_CSR_CH0A_d
K1_CS_CH0A_e:
    v_mfma_f32_16x16x32_bf16 v[128:131], v[20:23], v[48:51], v[128:131]
    v_mfma_f32_16x16x32_bf16 v[132:135], v[20:23], v[52:55], v[132:135]
    v_mfma_f32_16x16x32_bf16 v[136:139], v[20:23], v[56:59], v[136:139]
    v_mfma_f32_16x16x32_bf16 v[140:143], v[20:23], v[60:63], v[140:143]
    s_branch K1_CSR_CH0A_e
K1_CH0B:
.p2align 6
.p2align 6
K1_LOOP_CH0B:
    s_barrier
    v_mfma_f32_32x32x16_bf16 v[64:79], v[48:51], v[44:47], v[64:79]
    ds_read_b128 v[24:27], v10
    ds_read_b64_tr_b16 v[28:29], v14 offset:0
    ds_read_b64_tr_b16 v[30:31], v14 offset:256
    v_mfma_f32_32x32x16_bf16 v[80:95], v[52:55], v[44:47], v[80:95]
    ds_read_b64_tr_b16 v[32:33], v14 offset:4096
    ds_read_b64_tr_b16 v[34:35], v14 offset:4352
    ds_read_b64_tr_b16 v[36:37], v14 offset:8192
    ds_read_b64_tr_b16 v[38:39], v14 offset:8448
    v_mfma_f32_32x32x16_bf16 v[96:111], v[56:59], v[44:47], v[96:111]
    s_cmp_eq_u32 s31, 0
    s_cbranch_scc1 K1_CS_CH0B_a
K1_CSR_CH0B_a:
    s_waitcnt lgkmcnt(4)
    v_mfma_f32_32x32x16_bf16 v[64:79], v[28:31], v[24:27], v[64:79]
    ds_read_b128 v[44:47], v11
    ds_read_b64_tr_b16 v[48:49], v14 offset:1024
    ds_read_b64_tr_b16 v[50:51], v14 offset:1280
    s_waitcnt lgkmcnt(5)
    v_mfma_f32_32x32x16_bf16 v[80:95], v[32:35], v[24:27], v[80:95]
    ds_read_b64_tr_b16 v[52:53], v14 offset:5120
    ds_read_b64_tr_b16 v[54:55], v14 offset:5376
    ds_read_b64_tr_b16 v[56:57], v14 offset:9216
    ds_read_b64_tr_b16 v[58:59], v14 offset:9472
    s_waitcnt lgkmcnt(7)
    v_mfma_f32_32x32x16_bf16 v[96:111], v[36:39], v[24:27], v[96:111]
    s_cmp_eq_u32 s31, 1
    s_cbranch_scc1 K1_CS_CH0B_b
K1_CSR_CH0B_b:
    s_waitcnt lgkmcnt(4)
    v_mfma_f32_32x32x16_bf16 v[64:79], v[48:51], v[44:47], v[64:79]
    ds_read_b128 v[24:27], v12
    ds_read_b64_tr_b16 v[28:29], v14 offset:2048
    ds_read_b64_tr_b16 v[30:31], v14 offset:2304
    s_waitcnt lgkmcnt(5)
    v_mfma_f32_32x32x16_bf16 v[80:95], v[52:55], v[44:47], v[80:95]
    ds_read_b64_tr_b16 v[32:33], v14 offset:6144
    ds_read_b64_tr_b16 v[34:35], v14 offset:6400
    ds_read_b64_tr_b16 v[36:37], v14 offset:10240
    ds_read_b64_tr_b16 v[38:39], v14 offset:10496
    s_waitcnt lgkmcnt(7)
    v_mfma_f32_32x32x16_bf16 v[96:111], v[56:59], v[44:47], v[96:111]
    s_cmp_eq_u32 s31, 2
    s_cbranch_scc1 K1_CS_CH0B_c
K1_CSR_CH0B_c:
    s_waitcnt lgkmcnt(4)
    v_mfma_f32_32x32x16_bf16 v[64:79], v[28:31], v[24:27], v[64:79]
    ds_read_b128 v[44:47], v13
    ds_read_b64_tr_b16 v[48:49], v14 offset:3072
    ds_read_b64_tr_b16 v[50:51], v14 offset:3328
    ds_read_b64_tr_b16 v[52:53], v14 offset:7168
    s_waitcnt lgkmcnt(6)
    v_mfma_f32_32x32x16_bf16 v[80:95], v[32:35], v[24:27], v[80:95]
    ds_read_b64_tr_b16 v[54:55], v14 offset:7424
    ds_read_b64_tr_b16 v[56:57], v14 offset:11264
    ds_read_b64_tr_b16 v[58:59], v14 offset:11520
    s_waitcnt lgkmcnt(7)
    v_mfma_f32_32x32x16_bf16 v[96:111], v[36:39], v[24:27], v[96:111]
    s_cmp_eq_u32 s31, 3
    s_cbranch_scc1 K1_CS_CH0B_d
K1_CSR_CH0B_d:
    s_add_u32 s35, s35, 1
    s_cmp_eq_u32 s35, 3
    s_mov_b32 s34, 45056
    s_cselect_b32 s34, 4294877184, s34
    s_cselect_b32 s35, 0, s35
    v_add_u32 v10, s34, v10
    v_add_u32 v11, s34, v11
    v_add_u32 v12, s34, v12
    v_add_u32 v13, s34, v13
    v_add_u32 v14, s34, v14
    s_add_u32 s32, s32, 1
    s_cmp_lt_u32 s32, 10
    s_waitcnt lgkmcnt(0)
    s_cbranch_scc1 K1_LOOP_CH0B
    v_mfma_f32_32x32x16_bf16 v[64:79], v[48:51], v[44:47], v[64:79]
    v_mfma_f32_32x32x16_bf16 v[80:95], v[52:55], v[44:47], v[80:95]
    v_mfma_f32_32x32x16_bf16 v[96:111], v[56:59], v[44:47], v[96:111]
    s_cmp_eq_u32 s31, 0
    s_cbranch_scc1 K1_CS_CH0B_e
K1_CSR_CH0B_e:
    v_lshlrev_b32 v144, 4, v1
    s_lshl_b32 s58, s31, 2
    s_add_u32 s58, s58, 137216
    v_add_u32 v144, s58, v144
    s_nop 6
    s_mov_b64 exec, 0xffff
    ds_write_b32 v144, v128 offset:0
    ds_write_b32 v144, v129 offset:256
    ds_write_b32 v144, v132 offset:512
    ds_write_b32 v144, v133 offset:768
    ds_write_b32 v144, v136 offset:1024
    ds_write_b32 v144, v137 offset:1280
    s_mov_b64 exec, -1
    s_and_b32 s21, s21, 0xffff
    s_mov_b32 s22, 33554432
    s_mov_b32 s23, 0x00020000
    s_waitcnt lgkmcnt(0)
    s_barrier
    s_lshl_b32 s58, s31, 8
    s_add_u32 s58, s58, 135168
    v_lshl_add_u32 v144, v2, 3, s58
    ds_read_b64 v[148:149], v144
    ds_read_b64 v[150:151], v144 offset:1024
    v_lshlrev_b32 v145, 4, v2
    v_add_u32 v145, 137216, v145
    v_lshlrev_b32 v146, 2, v2
    v_add_u32 v146, 140800, v146
    ds_read_b128 v[44:47], v145 offset:0
    ds_read_b32 v36, v146 offset:0
    ds_read_b128 v[48:51], v145 offset:512
    ds_read_b32 v37, v146 offset:128
    ds_read_b128 v[52:55], v145 offset:1024
    ds_read_b32 v38, v146 offset:256
    v_cmp_eq_u32 vcc, 1, v3
    s_waitcnt lgkmcnt(0)
    v_add_f32 v15, v148, v150
    v_add_f32 v16, v149, v151
    v_mul_f32 v15, 0xbacccccd, v15
    v_mul_f32 v16, 0x3acccccd, v16
    v_fma_f32 v16, -v15, v15, v16
    v_max_f32 v16, 0, v16
    v_add_f32 v16, 0x3727c5ac, v16
    v_rsq_f32 v17, v16
    s_nop 0
    v_mul_f32 v16, v16, v17
    v_cvt_pk_bf16_f32 v24, v15, v15
    v_and_b32 v144, 0xffff0000, v24
    v_sub_f32 v144, v15, v144
    v_cvt_pk_bf16_f32 v25, v144, v16
    v_and_b32 v144, 0xffff0000, v25
    v_sub_f32 v144, v16, v144
    v_cvt_pk_bf16_f32 v144, v144, 0
    v_cndmask_b32 v24, v24, v144, vcc
    v_cndmask_b32_e64 v25, v25, 0, vcc
    v_add_f32 v44, v44, v45
    v_add_f32 v46, v46, v47
    v_add_f32 v44, v44, v46
    v_cvt_pk_bf16_f32 v45, v44, v44
    v_and_b32 v46, 0xffff0000, v45
    v_sub_f32 v46, v44, v46
    v_cvt_pk_bf16_f32 v28, v44, v46
    v_and_b32 v45, 0xffff, v45
    v_lshl_or_b32 v29, v36, 16, v45
    v_cndmask_b32 v28, v28, v36, vcc
    v_cndmask_b32_e64 v29, v29, 0, vcc
    v_add_f32 v48, v48, v49
    v_add_f32 v50, v50, v51
    v_add_f32 v48, v48, v50
    v_cvt_pk_bf16_f32 v49, v48, v48
    v_and_b32 v50, 0xffff0000, v49
    v_sub_f32 v50, v48, v50
    v_cvt_pk_bf16_f32 v30, v48, v50
    v_and_b32 v49, 0xffff, v49
    v_lshl_or_b32 v31, v37, 16, v49
    v_cndmask_b32 v30, v30, v37, vcc
    v_cndmask_b32_e64 v31, v31, 0, vcc
    v_add_f32 v52, v52, v53
    v_add_f32 v54, v54, v55
    v_add_f32 v52, v52, v54
    v_cvt_pk_bf16_f32 v53, v52, v52
    v_and_b32 v54, 0xffff0000, v53
    v_sub_f32 v54, v52, v54
    v_cvt_pk_bf16_f32 v32, v52, v54
    v_and_b32 v53, 0xffff, v53
    v_lshl_or_b32 v33, v38, 16, v53
    v_cndmask_b32 v32, v32, v38, vcc
    v_cndmask_b32_e64 v33, v33, 0, vcc
    s_nop 1
    v_mfma_f32_32x32x8_bf16 v[64:79], v[28:29], v[24:25], v[64:79]
    v_mfma_f32_32x32x8_bf16 v[80:95], v[30:31], v[24:25], v[80:95]
    v_mfma_f32_32x32x8_bf16 v[96:111], v[32:33], v[24:25], v[96:111]
    s_nop 7
    s_nop 3
    v_mul_f32 v64, v64, |v64|
    v_mul_f32 v65, v65, |v65|
    v_mul_f32 v66, v66, |v66|
    v_mul_f32 v67, v67, |v67|
    v_mul_f32 v68, v68, |v68|
    v_mul_f32 v69, v69, |v69|
    v_mul_f32 v70, v70, |v70|
    v_mul_f32 v71, v71, |v71|
    v_mul_f32 v72, v72, |v72|
    v_mul_f32 v73, v73, |v73|
    v_mul_f32 v74, v74, |v74|
    v_mul_f32 v75, v75, |v75|
    v_mul_f32 v76, v76, |v76|
    v_mul_f32 v77, v77, |v77|
    v_mul_f32 v78, v78, |v78|
    v_mul_f32 v79, v79, |v79|
    v_cvt_pk_bf16_f32 v44, v64, v65
    v_cvt_pk_bf16_f32 v45, v66, v67
    v_cvt_pk_bf16_f32 v46, v68, v69
    v_cvt_pk_bf16_f32 v47, v70, v71
    v_cvt_pk_bf16_f32 v48, v72, v73
    v_cvt_pk_bf16_f32 v49, v74, v75
    v_cvt_pk_bf16_f32 v50, v76, v77
    v_cvt_pk_bf16_f32 v51, v78, v79
    v_pk_max_i16 v44, v44, 0
    v_pk_max_i16 v45, v45, 0
    v_pk_max_i16 v46, v46, 0
    v_pk_max_i16 v47, v47, 0
    v_pk_max_i16 v48, v48, 0
    v_pk_max_i16 v49, v49, 0
    v_pk_max_i16 v50, v50, 0
    v_pk_max_i16 v51, v51, 0
    s_mul_i32 s58, s55, 96
    s_lshr_b32 s59, s48, 5
    s_add_u32 s58, s58, s59
    s_lshl_b32 s58, s58, 10
    s_add_u32 s58, s58, 7864320
    buffer_store_dwordx4 v[44:47], v4, s[20:23], s58 offen sc0 sc1
    buffer_store_dwordx4 v[48:51], v4, s[20:23], s58 offen offset:1024 sc0 sc1
    v_mul_f32 v80, v80, |v80|
    v_mul_f32 v81, v81, |v81|
    v_mul_f32 v82, v82, |v82|
    v_mul_f32 v83, v83, |v83|
    v_mul_f32 v84, v84, |v84|
    v_mul_f32 v85, v85, |v85|
    v_mul_f32 v86, v86, |v86|
    v_mul_f32 v87, v87, |v87|
    v_mul_f32 v88, v88, |v88|
    v_mul_f32 v89, v89, |v89|
    v_mul_f32 v90, v90, |v90|
    v_mul_f32 v91, v91, |v91|
    v_mul_f32 v92, v92, |v92|
    v_mul_f32 v93, v93, |v93|
    v_mul_f32 v94, v94, |v94|
    v_mul_f32 v95, v95, |v95|
    v_cvt_pk_bf16_f32 v52, v80, v81
    v_cvt_pk_bf16_f32 v53, v82, v83
    v_cvt_pk_bf16_f32 v54, v84, v85
    v_cvt_pk_bf16_f32 v55, v86, v87
    v_cvt_pk_bf16_f32 v56, v88, v89
    v_cvt_pk_bf16_f32 v57, v90, v91
    v_cvt_pk_bf16_f32 v58, v92, v93
    v_cvt_pk_bf16_f32 v59, v94, v95
    v_pk_max_i16 v52, v52, 0
    v_pk_max_i16 v53, v53, 0
    v_pk_max_i16 v54, v54, 0
    v_pk_max_i16 v55, v55, 0
    v_pk_max_i16 v56, v56, 0
    v_pk_max_i16 v57, v57, 0
    v_pk_max_i16 v58, v58, 0
    v_pk_max_i16 v59, v59, 0
    s_mul_i32 s58, s55, 96
    s_lshr_b32 s59, s49, 5
    s_add_u32 s58, s58, s59
    s_lshl_b32 s58, s58, 10
    s_add_u32 s58, s58, 7864320
    buffer_store_dwordx4 v[52:55], v4, s[20:23], s58 offen sc0 sc1
    buffer_store_dwordx4 v[56:59], v4, s[20:23], s58 offen offset:1024 sc0 sc1
    v_mul_f32 v96, v96, |v96|
    v_mul_f32 v97, v97, |v97|
    v_mul_f32 v98, v98, |v98|
    v_mul_f32 v99, v99, |v99|
    v_mul_f32 v100, v100, |v100|
    v_mul_f32 v101, v101, |v101|
    v_mul_f32 v102, v102, |v102|
    v_mul_f32 v103, v103, |v103|
    v_mul_f32 v104, v104, |v104|
    v_mul_f32 v105, v105, |v105|
    v_mul_f32 v106, v106, |v106|
    v_mul_f32 v107, v107, |v107|
    v_mul_f32 v108, v108, |v108|
    v_mul_f32 v109, v109, |v109|
    v_mul_f32 v110, v110, |v110|
    v_mul_f32 v111, v111, |v111|
    v_cvt_pk_bf16_f32 v44, v96, v97
    v_cvt_pk_bf16_f32 v45, v98, v99
    v_cvt_pk_bf16_f32 v46, v100, v101
    v_cvt_pk_bf16_f32 v47, v102, v103
    v_cvt_pk_bf16_f32 v48, v104, v105
    v_cvt_pk_bf16_f32 v49, v106, v107
    v_cvt_pk_bf16_f32 v50, v108, v109
    v_cvt_pk_bf16_f32 v51, v110, v111
    v_pk_max_i16 v44, v44, 0
    v_pk_max_i16 v45, v45, 0
    v_pk_max_i16 v46, v46, 0
    v_pk_max_i16 v47, v47, 0
    v_pk_max_i16 v48, v48, 0
    v_pk_max_i16 v49, v49, 0
    v_pk_max_i16 v50, v50, 0
    v_pk_max_i16 v51, v51, 0
    s_mul_i32 s58, s55, 96
    s_lshr_b32 s59, s50, 5
    s_add_u32 s58, s58, s59
    s_lshl_b32 s58, s58, 10
    s_add_u32 s58, s58, 7864320
    buffer_store_dwordx4 v[44:47], v4, s[20:23], s58 offen sc0 sc1
    buffer_store_dwordx4 v[48:51], v4, s[20:23], s58 offen offset:1024 sc0 sc1
    s_branch K1_FIN
K1_CS_CH0B_a:
    v_mfma_f32_16x16x32_bf16 v[128:131], v[20:23], v[48:51], v[128:131]
    v_mfma_f32_16x16x32_bf16 v[132:135], v[20:23], v[52:55], v[132:135]
    v_mfma_f32_16x16x32_bf16 v[136:139], v[20:23], v[56:59], v[136:139]
    s_branch K1_CSR_CH0B_a
K1_CS_CH0B_b:
    v_mfma_f32_16x16x32_bf16 v[128:131], v[20:23], v[28:31], v[128:131]
    v_mfma_f32_16x16x32_bf16 v[132:135], v[20:23], v[32:35], v[132:135]
    v_mfma_f32_16x16x32_bf16 v[136:139], v[20:23], v[36:39], v[136:139]
    s_branch K1_CSR_CH0B_b
K1_CS_CH0B_c:
    v_mfma_f32_16x16x32_bf16 v[128:131], v[20:23], v[48:51], v[128:131]
    v_mfma_f32_16x16x32_bf16 v[132:135], v[20:23], v[52:55], v[132:135]
    v_mfma_f32_16x16x32_bf16 v[136:139], v[20:23], v[56:59], v[136:139]
    s_branch K1_CSR_CH0B_c
K1_CS_CH0B_d:
    v_mfma_f32_16x16x32_bf16 v[128:131], v[20:23], v[28:31], v[128:131]
    v_mfma_f32_16x16x32_bf16 v[132:135], v[20:23], v[32:35], v[132:135]
    v_mfma_f32_16x16x32_bf16 v[136:139], v[20:23], v[36:39], v[136:139]
    s_branch K1_CSR_CH0B_d
K1_CS_CH0B_e:
    v_mfma_f32_16x16x32_bf16 v[128:131], v[20:23], v[48:51], v[128:131]
    v_mfma_f32_16x16x32_bf16 v[132:135], v[20:23], v[52:55], v[132:135]
    v_mfma_f32_16x16x32_bf16 v[136:139], v[20:23], v[56:59], v[136:139]
    s_branch K1_CSR_CH0B_e
K1_CH1:
    s_setprio 1
    s_cmp_ge_u32 s29, 12
    s_cbranch_scc1 K1_CH1B
K1_CH1A:
.p2align 6
.p2align 6
K1_LOOP_CH1A:
    s_barrier
    v_mfma_f32_32x32x16_bf16 v[64:79], v[48:51], v[44:47], v[64:79]
    ds_read_b128 v[24:27], v10
    ds_read_b64_tr_b16 v[28:29], v14 offset:256
    ds_read_b64_tr_b16 v[30:31], v14 offset:1536
    v_mfma_f32_32x32x16_bf16 v[80:95], v[52:55], v[44:47], v[80:95]
    ds_read_b64_tr_b16 v[32:33], v19 offset:0
    ds_read_b64_tr_b16 v[34:35], v19 offset:512
    ds_read_b64_tr_b16 v[36:37], v9 offset:0
    ds_read_b64_tr_b16 v[38:39], v9 offset:512
    v_mfma_f32_32x32x16_bf16 v[96:111], v[56:59], v[44:47], v[96:111]
    s_cmp_eq_u32 s31, 0
    s_cbranch_scc1 K1_CS_CH1A_a
K1_CSR_CH1A_a:
    s_waitcnt lgkmcnt(4)
    v_mfma_f32_32x32x16_bf16 v[64:79], v[28:31], v[24:27], v[64:79]
    ds_read_b128 v[44:47], v11
    ds_read_b64_tr_b16 v[48:49], v14 offset:5376
    ds_read_b64_tr_b16 v[50:51], v14 offset:6656
    s_waitcnt lgkmcnt(5)
    v_mfma_f32_32x32x16_bf16 v[80:95], v[32:35], v[24:27], v[80:95]
    ds_read_b64_tr_b16 v[52:53], v19 offset:2048
    ds_read_b64_tr_b16 v[54:55], v19 offset:2560
    ds_read_b64_tr_b16 v[56:57], v9 offset:2048
    ds_read_b64_tr_b16 v[58:59], v9 offset:2560
    s_waitcnt lgkmcnt(7)
    v_mfma_f32_32x32x16_bf16 v[96:111], v[36:39], v[24:27], v[96:111]
    s_cmp_eq_u32 s31, 1
    s_cbranch_scc1 K1_CS_CH1A_b
K1_CSR_CH1A_b:
    s_waitcnt lgkmcnt(4)
    v_mfma_f32_32x32x16_bf16 v[64:79], v[48:51], v[44:47], v[64:79]
    ds_read_b128 v[24:27], v12
    ds_read_b64_tr_b16 v[28:29], v14 offset:10496
    ds_read_b64_tr_b16 v[30:31], v14 offset:11776
    s_waitcnt lgkmcnt(5)
    v_mfma_f32_32x32x16_bf16 v[80:95], v[52:55], v[44:47], v[80:95]
    ds_read_b64_tr_b16 v[32:33], v19 offset:4096
    ds_read_b64_tr_b16 v[34:35], v19 offset:4608
    ds_read_b64_tr_b16 v[36:37], v9 offset:4096
    ds_read_b64_tr_b16 v[38:39], v9 offset:4608
    s_waitcnt lgkmcnt(7)
    v_mfma_f32_32x32x16_bf16 v[96:111], v[56:59], v[44:47], v[96:111]
    s_cmp_eq_u32 s31, 2
    s_cbranch_scc1 K1_CS_CH1A_c
K1_CSR_CH1A_c:
    s_waitcnt lgkmcnt(4)
    v_mfma_f32_32x32x16_bf16 v[64:79], v[28:31], v[24:27], v[64:79]
    ds_read_b128 v[44:47], v13
    ds_read_b64_tr_b16 v[48:49], v14 offset:15616
    ds_read_b64_tr_b16 v[50:51], v14 offset:16896
    ds_read_b64_tr_b16 v[52:53], v19 offset:6144
    s_waitcnt lgkmcnt(6)
    v_mfma_f32_32x32x16_bf16 v[80:95], v[32:35], v[24:27], v[80:95]
    ds_read_b64_tr_b16 v[54:55], v19 offset:6656
    ds_read_b64_tr_b16 v[56:57], v9 offset:6144
    ds_read_b64_tr_b16 v[58:59], v9 offset:6656
    s_waitcnt lgkmcnt(7)
    v_mfma_f32_32x32x16_bf16 v[96:111], v[36:39], v[24:27], v[96:111]
    s_cmp_eq_u32 s31, 3
    s_cbranch_scc1 K1_CS_CH1A_d
K1_CSR_CH1A_d:
    s_add_u32 s35, s35, 1
    s_cmp_eq_u32 s35, 3
    s_mov_b32 s34, 45056
    s_cselect_b32 s34, 4294877184, s34
    s_cselect_b32 s35, 0, s35
    v_add_u32 v10, s34, v10
    v_add_u32 v11, s34, v11
    v_add_u32 v12, s34, v12
    v_add_u32 v13, s34, v13
    v_add_u32 v14, s34, v14
    v_add_u32 v19, s34, v19
    v_add_u32 v9, s34, v9
    s_add_u32 s32, s32, 1
    s_cmp_lt_u32 s32, 10
    s_waitcnt lgkmcnt(0)
    s_cbranch_scc1 K1_LOOP_CH1A
    v_mfma_f32_32x32x16_bf16 v[64:79], v[48:51], v[44:47], v[64:79]
    v_mfma_f32_32x32x16_bf16 v[80:95], v[52:55], v[44:47], v[80:95]
    v_mfma_f32_32x32x16_bf16 v[96:111], v[56:59], v[44:47], v[96:111]
    s_cmp_eq_u32 s31, 0
    s_cbranch_scc1 K1_CS_CH1A_e
K1_CSR_CH1A_e:
    v_lshlrev_b32 v144, 4, v1
    s_lshl_b32 s58, s31, 2
    s_add_u32 s58, s58, 137216
    v_add_u32 v144, s58, v144
    s_nop 6
    s_mov_b64 exec, 0xffff
    ds_write_b32 v144, v128 offset:2048
    ds_write_b32 v144, v129 offset:2304
    ds_write_b32 v144, v132 offset:2560
    ds_write_b32 v144, v133 offset:2816
    ds_write_b32 v144, v136 offset:3072
    ds_write_b32 v144, v137 offset:3328
    s_mov_b64 exec, -1
    s_and_b32 s21, s21, 0xffff
    s_mov_b32 s22, 33554432
    s_mov_b32 s23, 0x00020000
    s_waitcnt lgkmcnt(0)
    s_barrier
    s_lshl_b32 s58, s31, 8
    s_add_u32 s58, s58, 135168
    v_lshl_add_u32 v144, v2, 3, s58
    ds_read_b64 v[148:149], v144
    ds_read_b64 v[150:151], v144 offset:1024
    v_lshlrev_b32 v145, 4, v2
    v_add_u32 v145, 137216, v145
    v_lshlrev_b32 v146, 2, v2
    v_add_u32 v146, 140800, v146
    ds_read_b128 v[44:47], v145 offset:2048
    v_mov_b32 v36, 0
    ds_read_b128 v[48:51], v145 offset:2560
    ds_read_b32 v37, v146 offset:640
    ds_read_b128 v[52:55], v145 offset:3072
    ds_read_b32 v38, v146 offset:768
    v_cmp_eq_u32 vcc, 1, v3
    s_waitcnt lgkmcnt(0)
    v_add_f32 v15, v148, v150
    v_add_f32 v16, v149, v151
    v_mul_f32 v15, 0xbacccccd, v15
    v_mul_f32 v16, 0x3acccccd, v16
    v_fma_f32 v16, -v15, v15, v16
    v_max_f32 v16, 0, v16
    v_add_f32 v16, 0x3727c5ac, v16
    v_rsq_f32 v17, v16
    s_nop 0
    v_mul_f32 v16, v16, v17
    v_cvt_pk_bf16_f32 v24, v15, v15
    v_and_b32 v144, 0xffff0000, v24
    v_sub_f32 v144, v15, v144
    v_cvt_pk_bf16_f32 v25, v144, v16
    v_and_b32 v144, 0xffff0000, v25
    v_sub_f32 v144, v16, v144
    v_cvt_pk_bf16_f32 v144, v144, 0
    v_cndmask_b32 v24, v24, v144, vcc
    v_cndmask_b32_e64 v25, v25, 0, vcc
    v_add_f32 v44, v44, v45
    v_add_f32 v46, v46, v47
    v_add_f32 v44, v44, v46
    v_cvt_pk_bf16_f32 v45, v44, v44
    v_and_b32 v46, 0xffff0000, v45
    v_sub_f32 v46, v44, v46
    v_cvt_pk_bf16_f32 v28, v44, v46
    v_and_b32 v45, 0xffff, v45
    v_lshl_or_b32 v29, v36, 16, v45
    v_cndmask_b32 v28, v28, v36, vcc
    v_cndmask_b32_e64 v29, v29, 0, vcc
    v_add_f32 v48, v48, v49
    v_add_f32 v50, v50, v51
    v_add_f32 v48, v48, v50
    v_cvt_pk_bf16_f32 v49, v48, v48
    v_and_b32 v50, 0xffff0000, v49
    v_sub_f32 v50, v48, v50
    v_cvt_pk_bf16_f32 v30, v48, v50
    v_and_b32 v49, 0xffff, v49
    v_lshl_or_b32 v31, v37, 16, v49
    v_cndmask_b32 v30, v30, v37, vcc
    v_cndmask_b32_e64 v31, v31, 0, vcc
    v_add_f32 v52, v52, v53
    v_add_f32 v54, v54, v55
    v_add_f32 v52, v52, v54
    v_cvt_pk_bf16_f32 v53, v52, v52
    v_and_b32 v54, 0xffff0000, v53
    v_sub_f32 v54, v52, v54
    v_cvt_pk_bf16_f32 v32, v52, v54
    v_and_b32 v53, 0xffff, v53
    v_lshl_or_b32 v33, v38, 16, v53
    v_cndmask_b32 v32, v32, v38, vcc
    v_cndmask_b32_e64 v33, v33, 0, vcc
    s_nop 1
    v_mfma_f32_32x32x8_bf16 v[64:79], v[28:29], v[24:25], v[64:79]
    v_mfma_f32_32x32x8_bf16 v[80:95], v[30:31], v[24:25], v[80:95]
    v_mfma_f32_32x32x8_bf16 v[96:111], v[32:33], v[24:25], v[96:111]
    s_lshl_b32 s58, s31, 5
    v_add_u32 v9, s58, v2
    v_mul_u32_u24 v6, 40, v9
    v_mul_u32_u24 v8, 328, v9
    v_mul_u32_u24 v9, 5088, v3
    v_add_u32 v7, v6, v9
    v_lshl_add_u32 v6, v3, 3, v6
    v_lshl_add_u32 v8, v3, 3, v8
    s_cmp_lt_u32 s29, 4
    s_cselect_b32 s60, 0x3ea52b5c, 1.0
    v_mul_f32 v152, s60, v17
    s_cmp_lg_u32 s29, 0
    s_cbranch_scc1 K1_NRS_CH1A
    v_mul_f32 v153, v17, v17
    s_lshl_b32 s58, s55, 7
    s_add_u32 s58, s58, 19857408
    v_lshlrev_b32 v154, 2, v2
    s_mov_b32 exec_hi, 0
    buffer_store_dword v153, v154, s[20:23], s58 offen sc0 sc1
    s_mov_b32 exec_hi, -1
K1_NRS_CH1A:
    s_nop 7
    s_nop 3
    v_pk_mul_f32 v[64:65], v[64:65], v[152:153] op_sel_hi:[1,0]
    v_pk_mul_f32 v[66:67], v[66:67], v[152:153] op_sel_hi:[1,0]
    v_pk_mul_f32 v[68:69], v[68:69], v[152:153] op_sel_hi:[1,0]
    v_pk_mul_f32 v[70:71], v[70:71], v[152:153] op_sel_hi:[1,0]
    v_pk_mul_f32 v[72:73], v[72:73], v[152:153] op_sel_hi:[1,0]
    v_pk_mul_f32 v[74:75], v[74:75], v[152:153] op_sel_hi:[1,0]
    v_pk_mul_f32 v[76:77], v[76:77], v[152:153] op_sel_hi:[1,0]
    v_pk_mul_f32 v[78:79], v[78:79], v[152:153] op_sel_hi:[1,0]
    v_cvt_pk_bf16_f32 v144, v64, v65
    v_cvt_pk_bf16_f32 v145, v66, v67
    v_cvt_pk_bf16_f32 v146, v68, v69
    v_cvt_pk_bf16_f32 v147, v70, v71
    v_cvt_pk_bf16_f32 v148, v72, v73
    v_cvt_pk_bf16_f32 v149, v74, v75
    v_cvt_pk_bf16_f32 v150, v76, v77
    v_cvt_pk_bf16_f32 v151, v78, v79
    s_cmp_ge_u32 s29, 8
    s_cbranch_scc1 K1_SV_CH1A_0
    ds_write_b64 v6, v[144:145] offset:30736
    ds_write_b64 v7, v[146:147] offset:30752
    ds_write_b64 v6, v[148:149] offset:35848
    ds_write_b64 v6, v[150:151] offset:35864
    s_branch K1_SE_CH1A_0
K1_SV_CH1A_0:
    ds_write_b64 v8, v[144:145] offset:256
    ds_write_b64 v8, v[146:147] offset:272
    ds_write_b64 v8, v[148:149] offset:288
    ds_write_b64 v8, v[150:151] offset:304
K1_SE_CH1A_0:
    v_mul_f32 v80, v80, |v80|
    v_mul_f32 v81, v81, |v81|
    v_mul_f32 v82, v82, |v82|
    v_mul_f32 v83, v83, |v83|
    v_mul_f32 v84, v84, |v84|
    v_mul_f32 v85, v85, |v85|
    v_mul_f32 v86, v86, |v86|
    v_mul_f32 v87, v87, |v87|
    v_mul_f32 v88, v88, |v88|
    v_mul_f32 v89, v89, |v89|
    v_mul_f32 v90, v90, |v90|
    v_mul_f32 v91, v91, |v91|
    v_mul_f32 v92, v92, |v92|
    v_mul_f32 v93, v93, |v93|
    v_mul_f32 v94, v94, |v94|
    v_mul_f32 v95, v95, |v95|
    v_cvt_pk_bf16_f32 v52, v80, v81
    v_cvt_pk_bf16_f32 v53, v82, v83
    v_cvt_pk_bf16_f32 v54, v84, v85
    v_cvt_pk_bf16_f32 v55, v86, v87
    v_cvt_pk_bf16_f32 v56, v88, v89
    v_cvt_pk_bf16_f32 v57, v90, v91
    v_cvt_pk_bf16_f32 v58, v92, v93
    v_cvt_pk_bf16_f32 v59, v94, v95
    v_pk_max_i16 v52, v52, 0
    v_pk_max_i16 v53, v53, 0
    v_pk_max_i16 v54, v54, 0
    v_pk_max_i16 v55, v55, 0
    v_pk_max_i16 v56, v56, 0
    v_pk_max_i16 v57, v57, 0
    v_pk_max_i16 v58, v58, 0
    v_pk_max_i16 v59, v59, 0
    s_mul_i32 s58, s55, 96
    s_lshr_b32 s59, s53, 5
    s_add_u32 s58, s58, s59
    s_lshl_b32 s58, s58, 10
    s_add_u32 s58, s58, 7864320
    buffer_store_dwordx4 v[52:55], v4, s[20:23], s58 offen sc0 sc1
    buffer_store_dwordx4 v[56:59], v4, s[20:23], s58 offen offset:1024 sc0 sc1
    v_mul_f32 v96, v96, |v96|
    v_mul_f32 v97, v97, |v97|
    v_mul_f32 v98, v98, |v98|
    v_mul_f32 v99, v99, |v99|
    v_mul_f32 v100, v100, |v100|
    v_mul_f32 v101, v101, |v101|
    v_mul_f32 v102, v102, |v102|
    v_mul_f32 v103, v103, |v103|
    v_mul_f32 v104, v104, |v104|
    v_mul_f32 v105, v105, |v105|
    v_mul_f32 v106, v106, |v106|
    v_mul_f32 v107, v107, |v107|
    v_mul_f32 v108, v108, |v108|
    v_mul_f32 v109, v109, |v109|
    v_mul_f32 v110, v110, |v110|
    v_mul_f32 v111, v111, |v111|
    v_cvt_pk_bf16_f32 v44, v96, v97
    v_cvt_pk_bf16_f32 v45, v98, v99
    v_cvt_pk_bf16_f32 v46, v100, v101
    v_cvt_pk_bf16_f32 v47, v102, v103
    v_cvt_pk_bf16_f32 v48, v104, v105
    v_cvt_pk_bf16_f32 v49, v106, v107
    v_cvt_pk_bf16_f32 v50, v108, v109
    v_cvt_pk_bf16_f32 v51, v110, v111
    v_pk_max_i16 v44, v44, 0
    v_pk_max_i16 v45, v45, 0
    v_pk_max_i16 v46, v46, 0
    v_pk_max_i16 v47, v47, 0
    v_pk_max_i16 v48, v48, 0
    v_pk_max_i16 v49, v49, 0
    v_pk_max_i16 v50, v50, 0
    v_pk_max_i16 v51, v51, 0
    s_mul_i32 s58, s55, 96
    s_lshr_b32 s59, s54, 5
    s_add_u32 s58, s58, s59
    s_lshl_b32 s58, s58, 10
    s_add_u32 s58, s58, 7864320
    buffer_store_dwordx4 v[44:47], v4, s[20:23], s58 offen sc0 sc1
    buffer_store_dwordx4 v[48:51], v4, s[20:23], s58 offen offset:1024 sc0 sc1
    s_waitcnt lgkmcnt(0)
    s_barrier
    s_branch K1_COPYOUT
K1_CS_CH1A_a:
    v_mfma_f32_16x16x32_bf16 v[128:131], v[20:23], v[48:51], v[128:131]
    v_mfma_f32_16x16x32_bf16 v[132:135], v[20:23], v[52:55], v[132:135]
    v_mfma_f32_16x16x32_bf16 v[136:139], v[20:23], v[56:59], v[136:139]
    s_branch K1_CSR_CH1A_a
K1_CS_CH1A_b:
    v_mfma_f32_16x16x32_bf16 v[128:131], v[20:23], v[28:31], v[128:131]
    v_mfma_f32_16x16x32_bf16 v[132:135], v[20:23], v[32:35], v[132:135]
    v_mfma_f32_16x16x32_bf16 v[136:139], v[20:23], v[36:39], v[136:139]
    s_branch K1_CSR_CH1A_b
K1_CS_CH1A_c:
    v_mfma_f32_16x16x32_bf16 v[128:131], v[20:23], v[48:51], v[128:131]
    v_mfma_f32_16x16x32_bf16 v[132:135], v[20:23], v[52:55], v[132:135]
    v_mfma_f32_16x16x32_bf16 v[136:139], v[20:23], v[56:59], v[136:139]
    s_branch K1_CSR_CH1A_c
K1_CS_CH1A_d:
    v_mfma_f32_16x16x32_bf16 v[128:131], v[20:23], v[28:31], v[128:131]
    v_mfma_f32_16x16x32_bf16 v[132:135], v[20:23], v[32:35], v[132:135]
    v_mfma_f32_16x16x32_bf16 v[136:139], v[20:23], v[36:39], v[136:139]
    s_branch K1_CSR_CH1A_d
K1_CS_CH1A_e:
    v_mfma_f32_16x16x32_bf16 v[128:131], v[20:23], v[48:51], v[128:131]
    v_mfma_f32_16x16x32_bf16 v[132:135], v[20:23], v[52:55], v[132:135]
    v_mfma_f32_16x16x32_bf16 v[136:139], v[20:23], v[56:59], v[136:139]
    s_branch K1_CSR_CH1A_e
K1_CH1B:
.p2align 6
.p2align 6
K1_LOOP_CH1B:
    s_barrier
    v_mfma_f32_32x32x16_bf16 v[64:79], v[48:51], v[44:47], v[64:79]
    ds_read_b128 v[24:27], v10
    ds_read_b64_tr_b16 v[28:29], v14 offset:16384
    ds_read_b64_tr_b16 v[30:31], v14 offset:16640
    v_mfma_f32_32x32x16_bf16 v[80:95], v[52:55], v[44:47], v[80:95]
    ds_read_b64_tr_b16 v[32:33], v14 offset:20480
    ds_read_b64_tr_b16 v[34:35], v14 offset:20736
    ds_read_b64_tr_b16 v[36:37], v14 offset:24576
    ds_read_b64_tr_b16 v[38:39], v14 offset:24832
    v_mfma_f32_32x32x16_bf16 v[96:111], v[56:59], v[44:47], v[96:111]
    s_cmp_eq_u32 s31, 0
    s_cbranch_scc1 K1_CS_CH1B_a
K1_CSR_CH1B_a:
    s_waitcnt lgkmcnt(4)
    v_mfma_f32_32x32x16_bf16 v[64:79], v[28:31], v[24:27], v[64:79]
    ds_read_b128 v[44:47], v11
    ds_read_b64_tr_b16 v[48:49], v14 offset:17408
    ds_read_b64_tr_b16 v[50:51], v14 offset:17664
    s_waitcnt lgkmcnt(5)
    v_mfma_f32_32x32x16_bf16 v[80:95], v[32:35], v[24:27], v[80:95]
    ds_read_b64_tr_b16 v[52:53], v14 offset:21504
    ds_read_b64_tr_b16 v[54:55], v14 offset:21760
    ds_read_b64_tr_b16 v[56:57], v14 offset:25600
    ds_read_b64_tr_b16 v[58:59], v14 offset:25856
    s_waitcnt lgkmcnt(7)
    v_mfma_f32_32x32x16_bf16 v[96:111], v[36:39], v[24:27], v[96:111]
    s_cmp_eq_u32 s31, 1
    s_cbranch_scc1 K1_CS_CH1B_b
K1_CSR_CH1B_b:
    s_waitcnt lgkmcnt(4)
    v_mfma_f32_32x32x16_bf16 v[64:79], v[48:51], v[44:47], v[64:79]
    ds_read_b128 v[24:27], v12
    ds_read_b64_tr_b16 v[28:29], v14 offset:18432
    ds_read_b64_tr_b16 v[30:31], v14 offset:18688
    s_waitcnt lgkmcnt(5)
    v_mfma_f32_32x32x16_bf16 v[80:95], v[52:55], v[44:47], v[80:95]
    ds_read_b64_tr_b16 v[32:33], v14 offset:22528
    ds_read_b64_tr_b16 v[34:35], v14 offset:22784
    ds_read_b64_tr_b16 v[36:37], v14 offset:26624
    ds_read_b64_tr_b16 v[38:39], v14 offset:26880
    s_waitcnt lgkmcnt(7)
    v_mfma_f32_32x32x16_bf16 v[96:111], v[56:59], v[44:47], v[96:111]
    s_cmp_eq_u32 s31, 2
    s_cbranch_scc1 K1_CS_CH1B_c
K1_CSR_CH1B_c:
    s_waitcnt lgkmcnt(4)
    v_mfma_f32_32x32x16_bf16 v[64:79], v[28:31], v[24:27], v[64:79]
    ds_read_b128 v[44:47], v13
    ds_read_b64_tr_b16 v[48:49], v14 offset:19456
    ds_read_b64_tr_b16 v[50:51], v14 offset:19712
    ds_read_b64_tr_b16 v[52:53], v14 offset:23552
    s_waitcnt lgkmcnt(6)
    v_mfma_f32_32x32x16_bf16 v[80:95], v[32:35], v[24:27], v[80:95]
    ds_read_b64_tr_b16 v[54:55], v14 offset:23808
    ds_read_b64_tr_b16 v[56:57], v14 offset:27648
    ds_read_b64_tr_b16 v[58:59], v14 offset:27904
    s_waitcnt lgkmcnt(7)
    v_mfma_f32_32x32x16_bf16 v[96:111], v[36:39], v[24:27], v[96:111]
    s_cmp_eq_u32 s31, 3
    s_cbranch_scc1 K1_CS_CH1B_d
K1_CSR_CH1B_d:
    s_add_u32 s35, s35, 1
    s_cmp_eq_u32 s35, 3
    s_mov_b32 s34, 45056
    s_cselect_b32 s34, 4294877184, s34
    s_cselect_b32 s35, 0, s35
    v_add_u32 v10, s34, v10
    v_add_u32 v11, s34, v11
    v_add_u32 v12, s34, v12
    v_add_u32 v13, s34, v13
    v_add_u32 v14, s34, v14
    s_add_u32 s32, s32, 1
    s_cmp_lt_u32 s32, 10
    s_waitcnt lgkmcnt(0)
    s_cbranch_scc1 K1_LOOP_CH1B
    v_mfma_f32_32x32x16_bf16 v[64:79], v[48:51], v[44:47], v[64:79]
    v_mfma_f32_32x32x16_bf16 v[80:95], v[52:55], v[44:47], v[80:95]
    v_mfma_f32_32x32x16_bf16 v[96:111], v[56:59], v[44:47], v[96:111]
    s_cmp_eq_u32 s31, 0
    s_cbranch_scc1 K1_CS_CH1B_e
K1_CSR_CH1B_e:
    v_lshlrev_b32 v144, 4, v1
    s_lshl_b32 s58, s31, 2
    s_add_u32 s58, s58, 137216
    v_add_u32 v144, s58, v144
    s_nop 6
    s_mov_b64 exec, 0xffff
    ds_write_b32 v144, v128 offset:2048
    ds_write_b32 v144, v129 offset:2304
    ds_write_b32 v144, v132 offset:2560
    ds_write_b32 v144, v133 offset:2816
    ds_write_b32 v144, v136 offset:3072
    ds_write_b32 v144, v137 offset:3328
    s_mov_b64 exec, -1
    s_and_b32 s21, s21, 0xffff
    s_mov_b32 s22, 33554432
    s_mov_b32 s23, 0x00020000
    s_waitcnt lgkmcnt(0)
    s_barrier
    s_lshl_b32 s58, s31, 8
    s_add_u32 s58, s58, 135168
    v_lshl_add_u32 v144, v2, 3, s58
    ds_read_b64 v[148:149], v144
    ds_read_b64 v[150:151], v144 offset:1024
    v_lshlrev_b32 v145, 4, v2
    v_add_u32 v145, 137216, v145
    v_lshlrev_b32 v146, 2, v2
    v_add_u32 v146, 140800, v146
    ds_read_b128 v[44:47], v145 offset:2048
    ds_read_b32 v36, v146 offset:512
    ds_read_b128 v[48:51], v145 offset:2560
    ds_read_b32 v37, v146 offset:640
    ds_read_b128 v[52:55], v145 offset:3072
    ds_read_b32 v38, v146 offset:768
    v_cmp_eq_u32 vcc, 1, v3
    s_waitcnt lgkmcnt(0)
    v_add_f32 v15, v148, v150
    v_add_f32 v16, v149, v151
    v_mul_f32 v15, 0xbacccccd, v15
    v_mul_f32 v16, 0x3acccccd, v16
    v_fma_f32 v16, -v15, v15, v16
    v_max_f32 v16, 0, v16
    v_add_f32 v16, 0x3727c5ac, v16
    v_rsq_f32 v17, v16
    s_nop 0
    v_mul_f32 v16, v16, v17
    v_cvt_pk_bf16_f32 v24, v15, v15
    v_and_b32 v144, 0xffff0000, v24
    v_sub_f32 v144, v15, v144
    v_cvt_pk_bf16_f32 v25, v144, v16
    v_and_b32 v144, 0xffff0000, v25
    v_sub_f32 v144, v16, v144
    v_cvt_pk_bf16_f32 v144, v144, 0
    v_cndmask_b32 v24, v24, v144, vcc
    v_cndmask_b32_e64 v25, v25, 0, vcc
    v_add_f32 v44, v44, v45
    v_add_f32 v46, v46, v47
    v_add_f32 v44, v44, v46
    v_cvt_pk_bf16_f32 v45, v44, v44
    v_and_b32 v46, 0xffff0000, v45
    v_sub_f32 v46, v44, v46
    v_cvt_pk_bf16_f32 v28, v44, v46
    v_and_b32 v45, 0xffff, v45
    v_lshl_or_b32 v29, v36, 16, v45
    v_cndmask_b32 v28, v28, v36, vcc
    v_cndmask_b32_e64 v29, v29, 0, vcc
    v_add_f32 v48, v48, v49
    v_add_f32 v50, v50, v51
    v_add_f32 v48, v48, v50
    v_cvt_pk_bf16_f32 v49, v48, v48
    v_and_b32 v50, 0xffff0000, v49
    v_sub_f32 v50, v48, v50
    v_cvt_pk_bf16_f32 v30, v48, v50
    v_and_b32 v49, 0xffff, v49
    v_lshl_or_b32 v31, v37, 16, v49
    v_cndmask_b32 v30, v30, v37, vcc
    v_cndmask_b32_e64 v31, v31, 0, vcc
    v_add_f32 v52, v52, v53
    v_add_f32 v54, v54, v55
    v_add_f32 v52, v52, v54
    v_cvt_pk_bf16_f32 v53, v52, v52
    v_and_b32 v54, 0xffff0000, v53
    v_sub_f32 v54, v52, v54
    v_cvt_pk_bf16_f32 v32, v52, v54
    v_and_b32 v53, 0xffff, v53
    v_lshl_or_b32 v33, v38, 16, v53
    v_cndmask_b32 v32, v32, v38, vcc
    v_cndmask_b32_e64 v33, v33, 0, vcc
    s_nop 1
    v_mfma_f32_32x32x8_bf16 v[64:79], v[28:29], v[24:25], v[64:79]
    v_mfma_f32_32x32x8_bf16 v[80:95], v[30:31], v[24:25], v[80:95]
    v_mfma_f32_32x32x8_bf16 v[96:111], v[32:33], v[24:25], v[96:111]
    s_cmp_lg_u32 s29, 0
    s_cbranch_scc1 K1_NRS_CH1B
    v_mul_f32 v153, v17, v17
    s_lshl_b32 s58, s55, 7
    s_add_u32 s58, s58, 19857408
    v_lshlrev_b32 v154, 2, v2
    s_mov_b32 exec_hi, 0
    buffer_store_dword v153, v154, s[20:23], s58 offen sc0 sc1
    s_mov_b32 exec_hi, -1
K1_NRS_CH1B:
    s_nop 7
    s_nop 3
    v_mul_f32 v64, v64, |v64|
    v_mul_f32 v65, v65, |v65|
    v_mul_f32 v66, v66, |v66|
    v_mul_f32 v67, v67, |v67|
    v_mul_f32 v68, v68, |v68|
    v_mul_f32 v69, v69, |v69|
    v_mul_f32 v70, v70, |v70|
    v_mul_f32 v71, v71, |v71|
    v_mul_f32 v72, v72, |v72|
    v_mul_f32 v73, v73, |v73|
    v_mul_f32 v74, v74, |v74|
    v_mul_f32 v75, v75, |v75|
    v_mul_f32 v76, v76, |v76|
    v_mul_f32 v77, v77, |v77|
    v_mul_f32 v78, v78, |v78|
    v_mul_f32 v79, v79, |v79|
    v_cvt_pk_bf16_f32 v44, v64, v65
    v_cvt_pk_bf16_f32 v45, v66, v67
    v_cvt_pk_bf16_f32 v46, v68, v69
    v_cvt_pk_bf16_f32 v47, v70, v71
    v_cvt_pk_bf16_f32 v48, v72, v73
    v_cvt_pk_bf16_f32 v49, v74, v75
    v_cvt_pk_bf16_f32 v50, v76, v77
    v_cvt_pk_bf16_f32 v51, v78, v79
    v_pk_max_i16 v44, v44, 0
    v_pk_max_i16 v45, v45, 0
    v_pk_max_i16 v46, v46, 0
    v_pk_max_i16 v47, v47, 0
    v_pk_max_i16 v48, v48, 0
    v_pk_max_i16 v49, v49, 0
    v_pk_max_i16 v50, v50, 0
    v_pk_max_i16 v51, v51, 0
    s_mul_i32 s58, s55, 96
    s_lshr_b32 s59, s52, 5
    s_add_u32 s58, s58, s59
    s_lshl_b32 s58, s58, 10
    s_add_u32 s58, s58, 7864320
    buffer_store_dwordx4 v[44:47], v4, s[20:23], s58 offen sc0 sc1
    buffer_store_dwordx4 v[48:51], v4, s[20:23], s58 offen offset:1024 sc0 sc1
    v_mul_f32 v80, v80, |v80|
    v_mul_f32 v81, v81, |v81|
    v_mul_f32 v82, v82, |v82|
    v_mul_f32 v83, v83, |v83|
    v_mul_f32 v84, v84, |v84|
    v_mul_f32 v85, v85, |v85|
    v_mul_f32 v86, v86, |v86|
    v_mul_f32 v87, v87, |v87|
    v_mul_f32 v88, v88, |v88|
    v_mul_f32 v89, v89, |v89|
    v_mul_f32 v90, v90, |v90|
    v_mul_f32 v91, v91, |v91|
    v_mul_f32 v92, v92, |v92|
    v_mul_f32 v93, v93, |v93|
    v_mul_f32 v94, v94, |v94|
    v_mul_f32 v95, v95, |v95|
    v_cvt_pk_bf16_f32 v52, v80, v81
    v_cvt_pk_bf16_f32 v53, v82, v83
    v_cvt_pk_bf16_f32 v54, v84, v85
    v_cvt_pk_bf16_f32 v55, v86, v87
    v_cvt_pk_bf16_f32 v56, v88, v89
    v_cvt_pk_bf16_f32 v57, v90, v91
    v_cvt_pk_bf16_f32 v58, v92, v93
    v_cvt_pk_bf16_f32 v59, v94, v95
    v_pk_max_i16 v52, v52, 0
    v_pk_max_i16 v53, v53, 0
    v_pk_max_i16 v54, v54, 0
    v_pk_max_i16 v55, v55, 0
    v_pk_max_i16 v56, v56, 0
    v_pk_max_i16 v57, v57, 0
    v_pk_max_i16 v58, v58, 0
    v_pk_max_i16 v59, v59, 0
    s_mul_i32 s58, s55, 96
    s_lshr_b32 s59, s53, 5
    s_add_u32 s58, s58, s59
    s_lshl_b32 s58, s58, 10
    s_add_u32 s58, s58, 7864320
    buffer_store_dwordx4 v[52:55], v4, s[20:23], s58 offen sc0 sc1
    buffer_store_dwordx4 v[56:59], v4, s[20:23], s58 offen offset:1024 sc0 sc1
    v_mul_f32 v96, v96, |v96|
    v_mul_f32 v97, v97, |v97|
    v_mul_f32 v98, v98, |v98|
    v_mul_f32 v99, v99, |v99|
    v_mul_f32 v100, v100, |v100|
    v_mul_f32 v101, v101, |v101|
    v_mul_f32 v102, v102, |v102|
    v_mul_f32 v103, v103, |v103|
    v_mul_f32 v104, v104, |v104|
    v_mul_f32 v105, v105, |v105|
    v_mul_f32 v106, v106, |v106|
    v_mul_f32 v107, v107, |v107|
    v_mul_f32 v108, v108, |v108|
    v_mul_f32 v109, v109, |v109|
    v_mul_f32 v110, v110, |v110|
    v_mul_f32 v111, v111, |v111|
    v_cvt_pk_bf16_f32 v44, v96, v97
    v_cvt_pk_bf16_f32 v45, v98, v99
    v_cvt_pk_bf16_f32 v46, v100, v101
    v_cvt_pk_bf16_f32 v47, v102, v103
    v_cvt_pk_bf16_f32 v48, v104, v105
    v_cvt_pk_bf16_f32 v49, v106, v107
    v_cvt_pk_bf16_f32 v50, v108, v109
    v_cvt_pk_bf16_f32 v51, v110, v111
    v_pk_max_i16 v44, v44, 0
    v_pk_max_i16 v45, v45, 0
    v_pk_max_i16 v46, v46, 0
    v_pk_max_i16 v47, v47, 0
    v_pk_max_i16 v48, v48, 0
    v_pk_max_i16 v49, v49, 0
    v_pk_max_i16 v50, v50, 0
    v_pk_max_i16 v51, v51, 0
    s_mul_i32 s58, s55, 96
    s_lshr_b32 s59, s54, 5
    s_add_u32 s58, s58, s59
    s_lshl_b32 s58, s58, 10
    s_add_u32 s58, s58, 7864320
    buffer_store_dwordx4 v[44:47], v4, s[20:23], s58 offen sc0 sc1
    buffer_store_dwordx4 v[48:51], v4, s[20:23], s58 offen offset:1024 sc0 sc1
    s_branch K1_FIN
K1_CS_CH1B_a:
    v_mfma_f32_16x16x32_bf16 v[128:131], v[20:23], v[48:51], v[128:131]
    v_mfma_f32_16x16x32_bf16 v[132:135], v[20:23], v[52:55], v[132:135]
    v_mfma_f32_16x16x32_bf16 v[136:139], v[20:23], v[56:59], v[136:139]
    s_branch K1_CSR_CH1B_a
K1_CS_CH1B_b:
    v_mfma_f32_16x16x32_bf16 v[128:131], v[20:23], v[28:31], v[128:131]
    v_mfma_f32_16x16x32_bf16 v[132:135], v[20:23], v[32:35], v[132:135]
    v_mfma_f32_16x16x32_bf16 v[136:139], v[20:23], v[36:39], v[136:139]
    s_branch K1_CSR_CH1B_b
K1_CS_CH1B_c:
    v_mfma_f32_16x16x32_bf16 v[128:131], v[20:23], v[48:51], v[128:131]
    v_mfma_f32_16x16x32_bf16 v[132:135], v[20:23], v[52:55], v[132:135]
    v_mfma_f32_16x16x32_bf16 v[136:139], v[20:23], v[56:59], v[136:139]
    s_branch K1_CSR_CH1B_c
K1_CS_CH1B_d:
    v_mfma_f32_16x16x32_bf16 v[128:131], v[20:23], v[28:31], v[128:131]
    v_mfma_f32_16x16x32_bf16 v[132:135], v[20:23], v[32:35], v[132:135]
    v_mfma_f32_16x16x32_bf16 v[136:139], v[20:23], v[36:39], v[136:139]
    s_branch K1_CSR_CH1B_d
K1_CS_CH1B_e:
    v_mfma_f32_16x16x32_bf16 v[128:131], v[20:23], v[48:51], v[128:131]
    v_mfma_f32_16x16x32_bf16 v[132:135], v[20:23], v[52:55], v[132:135]
    v_mfma_f32_16x16x32_bf16 v[136:139], v[20:23], v[56:59], v[136:139]
    s_branch K1_CSR_CH1B_e
K1_COPYOUT:
    s_cmp_ge_u32 s29, 8
    s_cbranch_scc1 K1_COV
    s_mul_i32 s58, s30, 5120
    v_add_u32 v5, s58, v4
    ds_read_b128 v[24:27], v5 offset:0
    ds_read_b128 v[28:31], v5 offset:1024
    ds_read_b128 v[32:35], v5 offset:2048
    ds_read_b128 v[36:39], v5 offset:3072
    ds_read_b128 v[40:43], v5 offset:4096
    s_lshl_b32 s58, s29, 3
    s_add_u32 s58, s58, s30
    s_cmp_ge_u32 s29, 4
    s_cbranch_scc1 K1_COK
    s_mul_i32 s58, s58, 81920
    s_mul_i32 s59, s28, 5120
    s_add_u32 s58, s58, s59
    s_add_u32 s58, s58, 0
    s_waitcnt lgkmcnt(0)
    buffer_store_dwordx4 v[24:27], v4, s[20:23], s58 offen offset:0 sc0 sc1
    buffer_store_dwordx4 v[28:31], v4, s[20:23], s58 offen offset:1024 sc0 sc1
    buffer_store_dwordx4 v[32:35], v4, s[20:23], s58 offen offset:2048 sc0 sc1
    buffer_store_dwordx4 v[36:39], v4, s[20:23], s58 offen offset:3072 sc0 sc1
    s_add_u32 s58, s58, 4096
    buffer_store_dwordx4 v[40:43], v4, s[20:23], s58 offen sc0 sc1
    s_branch K1_FIN
K1_COK:
    s_sub_u32 s58, s58, 32
    s_mul_i32 s58, s58, 163840
    s_mul_i32 s59, s28, 10240
    s_add_u32 s58, s58, s59
    s_add_u32 s58, s58, 2621440
    s_mov_b32 s61, 52429
    v_add_u32 v6, 0, v4
    v_lshrrev_b32 v7, 8, v6
    v_mul_lo_u32 v7, v7, s61
    v_lshrrev_b32 v7, 18, v7
    v_mul_u32_u24 v7, 1280, v7
    v_add_u32 v44, v6, v7
    v_add_u32 v6, 1024, v4
    v_lshrrev_b32 v7, 8, v6
    v_mul_lo_u32 v7, v7, s61
    v_lshrrev_b32 v7, 18, v7
    v_mul_u32_u24 v7, 1280, v7
    v_add_u32 v45, v6, v7
    v_add_u32 v6, 2048, v4
    v_lshrrev_b32 v7, 8, v6
    v_mul_lo_u32 v7, v7, s61
    v_lshrrev_b32 v7, 18, v7
    v_mul_u32_u24 v7, 1280, v7
    v_add_u32 v46, v6, v7
    v_add_u32 v6, 3072, v4
    v_lshrrev_b32 v7, 8, v6
    v_mul_lo_u32 v7, v7, s61
    v_lshrrev_b32 v7, 18, v7
    v_mul_u32_u24 v7, 1280, v7
    v_add_u32 v47, v6, v7
    v_add_u32 v6, 4096, v4
    v_lshrrev_b32 v7, 8, v6
    v_mul_lo_u32 v7, v7, s61
    v_lshrrev_b32 v7, 18, v7
    v_mul_u32_u24 v7, 1280, v7
    v_add_u32 v48, v6, v7
    s_waitcnt lgkmcnt(0)
    buffer_store_dwordx4 v[24:27], v44, s[20:23], s58 offen sc0 sc1
    buffer_store_dwordx4 v[28:31], v45, s[20:23], s58 offen sc0 sc1
    buffer_store_dwordx4 v[32:35], v46, s[20:23], s58 offen sc0 sc1
    buffer_store_dwordx4 v[36:39], v47, s[20:23], s58 offen sc0 sc1
    buffer_store_dwordx4 v[40:43], v48, s[20:23], s58 offen sc0 sc1
    s_branch K1_FIN
K1_COV:
    v_lshrrev_b32 v5, 4, v1
    v_and_b32 v6, 1, v5
    v_lshrrev_b32 v7, 1, v5
    v_bfe_u32 v8, v1, 2, 2
    v_lshl_add_u32 v8, v6, 2, v8
    s_lshl_b32 s58, s30, 4
    v_add_u32 v8, s58, v8
    v_mul_u32_u24 v8, 328, v8
    v_and_b32 v9, 3, v1
    v_lshl_add_u32 v8, v9, 3, v8
    v_lshl_add_u32 v8, v7, 5, v8
    ds_read_b64_tr_b16 v[24:25], v8 offset:0
    ds_read_b64_tr_b16 v[26:27], v8 offset:2624
    ds_read_b64_tr_b16 v[28:29], v8 offset:64
    ds_read_b64_tr_b16 v[30:31], v8 offset:2688
    ds_read_b64_tr_b16 v[32:33], v8 offset:128
    ds_read_b64_tr_b16 v[34:35], v8 offset:2752
    ds_read_b64_tr_b16 v[36:37], v8 offset:192
    ds_read_b64_tr_b16 v[38:39], v8 offset:2816
    ds_read_b64_tr_b16 v[40:41], v8 offset:256
    ds_read_b64_tr_b16 v[42:43], v8 offset:2880
    v_and_b32 v9, 15, v1
    v_lshl_add_u32 v9, v7, 4, v9
    v_mul_u32_u24 v6, 320, v6
    s_mov_b32 s61, 52429
    s_mov_b32 s62, 163840
    v_add_u32 v5, 0, v9
    v_mul_lo_u32 v7, v5, s61
    v_lshrrev_b32 v7, 20, v7
    v_mul_u32_u24 v8, 20, v7
    v_sub_u32 v5, v5, v8
    v_mul_lo_u32 v7, v7, s62
    v_lshl_add_u32 v5, v5, 4, v7
    v_add_u32 v44, v5, v6
    v_add_u32 v5, 32, v9
    v_mul_lo_u32 v7, v5, s61
    v_lshrrev_b32 v7, 20, v7
    v_mul_u32_u24 v8, 20, v7
    v_sub_u32 v5, v5, v8
    v_mul_lo_u32 v7, v7, s62
    v_lshl_add_u32 v5, v5, 4, v7
    v_add_u32 v45, v5, v6
    v_add_u32 v5, 64, v9
    v_mul_lo_u32 v7, v5, s61
    v_lshrrev_b32 v7, 20, v7
    v_mul_u32_u24 v8, 20, v7
    v_sub_u32 v5, v5, v8
    v_mul_lo_u32 v7, v7, s62
    v_lshl_add_u32 v5, v5, 4, v7
    v_add_u32 v46, v5, v6
    v_add_u32 v5, 96, v9
    v_mul_lo_u32 v7, v5, s61
    v_lshrrev_b32 v7, 20, v7
    v_mul_u32_u24 v8, 20, v7
    v_sub_u32 v5, v5, v8
    v_mul_lo_u32 v7, v7, s62
    v_lshl_add_u32 v5, v5, 4, v7
    v_add_u32 v47, v5, v6
    v_add_u32 v5, 128, v9
    v_mul_lo_u32 v7, v5, s61
    v_lshrrev_b32 v7, 20, v7
    v_mul_u32_u24 v8, 20, v7
    v_sub_u32 v5, v5, v8
    v_mul_lo_u32 v7, v7, s62
    v_lshl_add_u32 v5, v5, 4, v7
    v_add_u32 v48, v5, v6
    s_sub_u32 s58, s29, 8
    s_mul_i32 s58, s58, 1310720
    s_lshr_b32 s59, s30, 1
    s_lshl_b32 s60, s28, 2
    s_add_u32 s59, s59, s60
    s_mul_i32 s59, s59, 2560
    s_add_u32 s58, s58, s59
    s_and_b32 s59, s30, 1
    s_mul_i32 s59, s59, 640
    s_add_u32 s58, s58, s59
    s_add_u32 s58, s58, 2622720
    s_waitcnt lgkmcnt(0)
    buffer_store_dwordx4 v[24:27], v44, s[20:23], s58 offen sc0 sc1
    buffer_store_dwordx4 v[28:31], v45, s[20:23], s58 offen sc0 sc1
    buffer_store_dwordx4 v[32:35], v46, s[20:23], s58 offen sc0 sc1
    buffer_store_dwordx4 v[36:39], v47, s[20:23], s58 offen sc0 sc1
    buffer_store_dwordx4 v[40:43], v48, s[20:23], s58 offen sc0 sc1
K1_FIN:
    s_endpgm
K1_LOADER:
    s_setprio 3
    v_lshrrev_b32 v9, 3, v1
    v_mul_u32_u24 v7, 1280, v9
    v_lshrrev_b32 v9, 4, v1
    v_and_b32 v13, 7, v1
    v_xor_b32 v14, v13, v9
    v_lshlrev_b32 v14, 4, v14
    v_xor_b32 v9, 4, v9
    v_xor_b32 v9, v13, v9
    v_lshlrev_b32 v9, 4, v9
    v_add_u32 v8, v7, v9
    v_add_u32 v7, v7, v14
    s_mov_b32 s33, 0
    s_lshl_b32 s58, s28, 7
    s_lshl_b32 s59, s31, 5
    s_add_u32 s58, s58, s59
    s_mul_i32 s58, s58, 1280
    s_add_u32 s36, s58, 0
    s_add_u32 s37, s58, 10240
    s_add_u32 s38, s58, 20480
    s_add_u32 s39, s58, 30720
    s_lshr_b32 s58, s2, 3
    s_lshr_b32 s59, s58, 3
    s_and_b32 s58, s58, 7
    s_mul_i32 s59, s59, 3
    s_add_u32 s58, s58, s59
    s_cmp_ge_u32 s58, 10
    s_cselect_b32 s59, 10, 0
    s_sub_u32 s70, s58, s59
    s_cmp_ge_u32 s70, 10
    s_cselect_b32 s59, 10, 0
    s_sub_u32 s70, s70, s59
    s_lshl_b32 s59, s70, 7
    s_add_u32 s36, s36, s59
    s_add_u32 s37, s37, s59
    s_add_u32 s38, s38, s59
    s_add_u32 s39, s39, s59
    s_waitcnt lgkmcnt(0)
    s_mov_b32 s8, s4
    s_and_b32 s9, s5, 0xffff
    s_mov_b32 s10, 2621440
    s_mov_b32 s11, 0x00020000
    s_lshl_b32 s58, s31, 12
    s_add_u32 m0, s58, 0
    s_nop 0
    buffer_load_dwordx4 v7, s[8:11], s36 offen lds
    s_add_u32 m0, s58, 1024
    s_nop 0
    buffer_load_dwordx4 v8, s[8:11], s37 offen lds
    s_add_u32 m0, s58, 2048
    s_nop 0
    buffer_load_dwordx4 v7, s[8:11], s38 offen lds
    s_add_u32 m0, s58, 3072
    s_nop 0
    buffer_load_dwordx4 v8, s[8:11], s39 offen lds
    v_lshrrev_b32 v9, 2, v1
    v_and_b32 v13, 3, v1
    v_lshlrev_b32 v13, 4, v13
    v_mul_u32_u24 v5, 3840, v9
    v_add_u32 v5, v5, v13
    v_mul_u32_u24 v6, 3072, v9
    v_add_u32 v6, v6, v13
    v_add_u32 v9, 0, v4
    v_lshrrev_b32 v13, 6, v9
    v_mul_u32_u24 v13, 52429, v13
    v_lshrrev_b32 v13, 18, v13
    v_mul_u32_u24 v14, 320, v13
    v_sub_u32 v14, v9, v14
    v_mul_u32_u24 v13, 3840, v13
    v_add_u32 v20, v13, v14
    v_add_u32 v9, 1024, v4
    v_lshrrev_b32 v13, 6, v9
    v_mul_u32_u24 v13, 52429, v13
    v_lshrrev_b32 v13, 18, v13
    v_mul_u32_u24 v14, 320, v13
    v_sub_u32 v14, v9, v14
    v_mul_u32_u24 v13, 3840, v13
    v_add_u32 v21, v13, v14
    v_add_u32 v9, 2048, v4
    v_lshrrev_b32 v13, 6, v9
    v_mul_u32_u24 v13, 52429, v13
    v_lshrrev_b32 v13, 18, v13
    v_mul_u32_u24 v14, 320, v13
    v_sub_u32 v14, v9, v14
    v_mul_u32_u24 v13, 3840, v13
    v_add_u32 v22, v13, v14
    v_add_u32 v9, 3072, v4
    v_lshrrev_b32 v13, 6, v9
    v_mul_u32_u24 v13, 52429, v13
    v_lshrrev_b32 v13, 18, v13
    v_mul_u32_u24 v14, 320, v13
    v_sub_u32 v14, v9, v14
    v_mul_u32_u24 v13, 3840, v13
    v_add_u32 v23, v13, v14
    v_add_u32 v9, 4096, v4
    v_lshrrev_b32 v13, 6, v9
    v_mul_u32_u24 v13, 52429, v13
    v_lshrrev_b32 v13, 18, v13
    v_mul_u32_u24 v14, 320, v13
    v_sub_u32 v14, v9, v14
    v_mul_u32_u24 v13, 3840, v13
    v_add_u32 v24, v13, v14
    v_lshrrev_b32 v9, 3, v1
    v_mul_u32_u24 v25, 3072, v9
    v_bfe_u32 v9, v1, 4, 1
    v_lshlrev_b32 v9, 2, v9
    v_and_b32 v13, 7, v1
    v_xor_b32 v9, v9, v13
    v_lshl_add_u32 v25, v9, 4, v25
    s_mul_i32 s58, s31, 61440
    s_mul_i32 s59, s31, 49152
    s_cmp_ge_u32 s29, 12
    s_cselect_b32 s58, s59, s58
    s_add_u32 s40, s58, s48
    s_add_u32 s41, s58, s49
    s_add_u32 s42, s58, s50
    s_add_u32 s43, s58, s51
    s_add_u32 s44, s58, s52
    s_add_u32 s45, s59, s53
    s_add_u32 s46, s59, s54
    s_mov_b32 s58, 245760
    s_cmp_ge_u32 s29, 12
    s_cselect_b32 s58, 196608, s58
    s_mul_i32 s58, s58, s70
    s_mul_i32 s59, s70, 196608
    s_add_u32 s40, s40, s58
    s_add_u32 s41, s41, s58
    s_add_u32 s42, s42, s58
    s_add_u32 s43, s43, s58
    s_add_u32 s44, s44, s58
    s_add_u32 s45, s45, s59
    s_add_u32 s46, s46, s59
    s_cmp_ge_u32 s29, 12
    s_cbranch_scc1 K1_LOLD
    s_add_u32 s46, s45, 24576
K1_LOLD:
    s_mov_b32 s16, s64
    s_and_b32 s17, s65, 0xffff
    s_mov_b32 s18, 1966080
    s_mov_b32 s19, 0x00020000
    s_and_b32 s21, s21, 0xffff
    s_mov_b32 s22, 33554432
    s_mov_b32 s23, 0x00020000
    s_cmp_ge_u32 s29, 12
    s_cselect_b32 s12, s64, s6
    s_cselect_b32 s13, s65, s7
    s_and_b32 s13, s13, 0xffff
    s_cmp_ge_u32 s29, 12
    s_mov_b32 s14, 2457600
    s_cselect_b32 s14, 1966080, s14
    s_mov_b32 s15, 0x00020000
    s_mov_b32 s68, 245760
    s_cselect_b32 s68, 196608, s68
    s_cselect_b32 s69, 0, 1
    s_cselect_b64 vcc, -1, 0
    v_cndmask_b32 v15, v5, v6, vcc
    s_cmp_ge_u32 s29, 12
    s_cbranch_scc1 K1_DO_p0
    s_add_u32 s70, s70, 1
    s_cmp_eq_u32 s70, 10
    s_cselect_b32 s70, 0, s70
    s_mov_b32 s71, 128
    s_cselect_b32 s71, 4294966144, s71
    s_mul_i32 s86, s68, -9
    s_cselect_b32 s86, s86, s68
    s_mov_b32 s87, 196608
    s_cselect_b32 s87, 4293197824, s87
    s_lshl_b32 s58, s31, 12
    s_add_u32 s58, s58, s33
    s_add_u32 s36, s36, s71
    s_add_u32 s37, s37, s71
    s_add_u32 s38, s38, s71
    s_add_u32 s39, s39, s71
    s_mul_i32 s58, s31, 5120
    s_add_u32 s58, s58, s33
    s_lshl_b32 s59, s31, 11
    s_add_u32 s59, s59, s33
    s_add_u32 m0, s58, 16384
    s_nop 0
    buffer_load_dwordx4 v20, s[12:15], s40 offen lds
    s_add_u32 m0, s58, 17408
    s_nop 0
    buffer_load_dwordx4 v21, s[12:15], s40 offen lds
    s_add_u32 m0, s58, 18432
    s_nop 0
    buffer_load_dwordx4 v22, s[12:15], s40 offen lds
    s_add_u32 m0, s58, 19456
    s_nop 0
    buffer_load_dwordx4 v23, s[12:15], s40 offen lds
    s_add_u32 m0, s58, 20480
    s_nop 0
    buffer_load_dwordx4 v24, s[12:15], s40 offen lds
    s_add_u32 s40, s40, s86
    s_add_u32 m0, s59, 36864
    s_nop 0
    buffer_load_dwordx4 v25, s[16:19], s45 offen lds
    s_add_u32 s45, s45, s87
    s_add_u32 m0, s59, 37888
    s_nop 0
    buffer_load_dwordx4 v25, s[16:19], s46 offen lds
    s_add_u32 s46, s46, s87
    s_add_u32 s33, s33, 45056
    s_cmp_eq_u32 s33, 135168
    s_cselect_b32 s33, 0, s33
    s_branch K1_DE_p0
K1_DO_p0:
    s_add_u32 s70, s70, 1
    s_cmp_eq_u32 s70, 10
    s_cselect_b32 s70, 0, s70
    s_mov_b32 s71, 128
    s_cselect_b32 s71, 4294966144, s71
    s_mul_i32 s86, s68, -9
    s_cselect_b32 s86, s86, s68
    s_mov_b32 s87, 196608
    s_cselect_b32 s87, 4293197824, s87
    s_lshl_b32 s58, s31, 12
    s_add_u32 s58, s58, s33
    s_add_u32 s36, s36, s71
    s_add_u32 s37, s37, s71
    s_add_u32 s38, s38, s71
    s_add_u32 s39, s39, s71
    s_lshl_b32 s58, s31, 10
    s_add_u32 s58, s58, s33
    s_add_u32 m0, s58, 16384
    s_nop 0
    buffer_load_dwordx4 v15, s[12:15], s40 offen lds
    s_add_u32 s40, s40, s86
    s_add_u32 m0, s58, 20480
    s_nop 0
    buffer_load_dwordx4 v15, s[12:15], s41 offen lds
    s_add_u32 s41, s41, s86
    s_add_u32 m0, s58, 24576
    s_nop 0
    buffer_load_dwordx4 v15, s[12:15], s42 offen lds
    s_add_u32 s42, s42, s86
    s_add_u32 m0, s58, 28672
    s_nop 0
    buffer_load_dwordx4 v15, s[12:15], s43 offen lds
    s_add_u32 s43, s43, s86
    s_add_u32 m0, s58, 32768
    s_nop 0
    buffer_load_dwordx4 v15, s[12:15], s44 offen lds
    s_add_u32 s44, s44, s86
    s_add_u32 m0, s58, 36864
    s_nop 0
    buffer_load_dwordx4 v6, s[16:19], s45 offen lds
    s_add_u32 s45, s45, s87
    s_add_u32 m0, s58, 40960
    s_nop 0
    buffer_load_dwordx4 v6, s[16:19], s46 offen lds
    s_add_u32 s46, s46, s87
    s_add_u32 s33, s33, 45056
    s_cmp_eq_u32 s33, 135168
    s_cselect_b32 s33, 0, s33
K1_DE_p0:
    s_cmp_ge_u32 s29, 12
    s_cbranch_scc1 K1_DO_p1
    s_add_u32 s70, s70, 1
    s_cmp_eq_u32 s70, 10
    s_cselect_b32 s70, 0, s70
    s_mov_b32 s71, 128
    s_cselect_b32 s71, 4294966144, s71
    s_mul_i32 s86, s68, -9
    s_cselect_b32 s86, s86, s68
    s_mov_b32 s87, 196608
    s_cselect_b32 s87, 4293197824, s87
    s_lshl_b32 s58, s31, 12
    s_add_u32 s58, s58, s33
    s_add_u32 m0, s58, 0
    s_nop 0
    buffer_load_dwordx4 v7, s[8:11], s36 offen lds
    s_add_u32 m0, s58, 1024
    s_add_u32 s36, s36, s71
    buffer_load_dwordx4 v8, s[8:11], s37 offen lds
    s_add_u32 m0, s58, 2048
    s_add_u32 s37, s37, s71
    buffer_load_dwordx4 v7, s[8:11], s38 offen lds
    s_add_u32 m0, s58, 3072
    s_add_u32 s38, s38, s71
    buffer_load_dwordx4 v8, s[8:11], s39 offen lds
    s_add_u32 s39, s39, s71
    s_mul_i32 s58, s31, 5120
    s_add_u32 s58, s58, s33
    s_lshl_b32 s59, s31, 11
    s_add_u32 s59, s59, s33
    s_add_u32 m0, s58, 16384
    s_nop 0
    buffer_load_dwordx4 v20, s[12:15], s40 offen lds
    s_add_u32 m0, s58, 17408
    s_nop 0
    buffer_load_dwordx4 v21, s[12:15], s40 offen lds
    s_add_u32 m0, s58, 18432
    s_nop 0
    buffer_load_dwordx4 v22, s[12:15], s40 offen lds
    s_add_u32 m0, s58, 19456
    s_nop 0
    buffer_load_dwordx4 v23, s[12:15], s40 offen lds
    s_add_u32 m0, s58, 20480
    s_nop 0
    buffer_load_dwordx4 v24, s[12:15], s40 offen lds
    s_add_u32 s40, s40, s86
    s_add_u32 m0, s59, 36864
    s_nop 0
    buffer_load_dwordx4 v25, s[16:19], s45 offen lds
    s_add_u32 s45, s45, s87
    s_add_u32 m0, s59, 37888
    s_nop 0
    buffer_load_dwordx4 v25, s[16:19], s46 offen lds
    s_add_u32 s46, s46, s87
    s_add_u32 s33, s33, 45056
    s_cmp_eq_u32 s33, 135168
    s_cselect_b32 s33, 0, s33
    s_branch K1_DE_p1
K1_DO_p1:
    s_add_u32 s70, s70, 1
    s_cmp_eq_u32 s70, 10
    s_cselect_b32 s70, 0, s70
    s_mov_b32 s71, 128
    s_cselect_b32 s71, 4294966144, s71
    s_mul_i32 s86, s68, -9
    s_cselect_b32 s86, s86, s68
    s_mov_b32 s87, 196608
    s_cselect_b32 s87, 4293197824, s87
    s_lshl_b32 s58, s31, 12
    s_add_u32 s58, s58, s33
    s_add_u32 m0, s58, 0
    s_nop 0
    buffer_load_dwordx4 v7, s[8:11], s36 offen lds
    s_add_u32 m0, s58, 1024
    s_add_u32 s36, s36, s71
    buffer_load_dwordx4 v8, s[8:11], s37 offen lds
    s_add_u32 m0, s58, 2048
    s_add_u32 s37, s37, s71
    buffer_load_dwordx4 v7, s[8:11], s38 offen lds
    s_add_u32 m0, s58, 3072
    s_add_u32 s38, s38, s71
    buffer_load_dwordx4 v8, s[8:11], s39 offen lds
    s_add_u32 s39, s39, s71
    s_lshl_b32 s58, s31, 10
    s_add_u32 s58, s58, s33
    s_add_u32 m0, s58, 16384
    s_nop 0
    buffer_load_dwordx4 v15, s[12:15], s40 offen lds
    s_add_u32 s40, s40, s86
    s_add_u32 m0, s58, 20480
    s_nop 0
    buffer_load_dwordx4 v15, s[12:15], s41 offen lds
    s_add_u32 s41, s41, s86
    s_add_u32 m0, s58, 24576
    s_nop 0
    buffer_load_dwordx4 v15, s[12:15], s42 offen lds
    s_add_u32 s42, s42, s86
    s_add_u32 m0, s58, 28672
    s_nop 0
    buffer_load_dwordx4 v15, s[12:15], s43 offen lds
    s_add_u32 s43, s43, s86
    s_add_u32 m0, s58, 32768
    s_nop 0
    buffer_load_dwordx4 v15, s[12:15], s44 offen lds
    s_add_u32 s44, s44, s86
    s_add_u32 m0, s58, 36864
    s_nop 0
    buffer_load_dwordx4 v6, s[16:19], s45 offen lds
    s_add_u32 s45, s45, s87
    s_add_u32 m0, s58, 40960
    s_nop 0
    buffer_load_dwordx4 v6, s[16:19], s46 offen lds
    s_add_u32 s46, s46, s87
    s_add_u32 s33, s33, 45056
    s_cmp_eq_u32 s33, 135168
    s_cselect_b32 s33, 0, s33
K1_DE_p1:
    s_cmp_lg_u32 s2, 0
    s_cbranch_scc1 K1_NOZ
    s_cmp_lg_u32 s31, 0
    s_cbranch_scc1 K1_NOZ
    v_lshlrev_b32 v9, 8, v1
    v_mov_b32 v13, 0
    s_mov_b32 s58, 0x12F4000
    s_mov_b64 exec, 0xff
    buffer_store_dword v13, v9, s[20:23], s58 offen sc0 sc1
    s_mov_b64 exec, -1
K1_NOZ:
    v_lshrrev_b32 v9, 1, v2
    v_and_b32 v9, 7, v9
    s_lshl_b32 s58, s31, 12
    v_lshlrev_b32 v13, 7, v2
    v_add_u32 v13, s58, v13
    v_add_u32 v14, 0, v3
    v_xor_b32 v14, v14, v9
    v_lshl_add_u32 v40, v14, 4, v13
    v_add_u32 v14, 2, v3
    v_xor_b32 v14, v14, v9
    v_lshl_add_u32 v41, v14, 4, v13
    v_add_u32 v14, 4, v3
    v_xor_b32 v14, v14, v9
    v_lshl_add_u32 v42, v14, 4, v13
    v_add_u32 v14, 6, v3
    v_xor_b32 v14, v14, v9
    v_lshl_add_u32 v43, v14, 4, v13
    v_mov_b32 v44, 0
    v_mov_b32 v45, 0
    v_mov_b32 v46, 0
    v_mov_b32 v47, 0
    s_mov_b32 s35, 0
    s_cmp_eq_u32 s31, 0
    s_cselect_b32 s58, s48, s50
    s_cselect_b32 s59, s49, s51
    s_cmp_eq_u32 s31, 2
    s_cselect_b32 s58, s52, s58
    s_cselect_b32 s59, s53, s59
    s_cmp_eq_u32 s31, 3
    s_cselect_b32 s58, s54, s58
    s_cselect_b32 s59, s54, s59
    v_mov_b32 v9, s58
    v_mov_b32 v13, s59
    v_cmp_eq_u32 vcc, 1, v3
    s_nop 1
    v_cndmask_b32 v9, v9, v13, vcc
    v_lshl_add_u32 v9, v2, 1, v9
    v_min_u32 v9, 3070, v9
    global_load_ushort v16, v9, s[66:67]
K1_LLOOP:
    s_cmp_eq_u32 s32, 0
    s_cbranch_scc1 K1_LW0
    s_cmp_eq_u32 s32, 9
    s_cbranch_scc1 K1_LW9
    s_waitcnt vmcnt(11)
    s_branch K1_LWD
K1_LW0:
    s_waitcnt vmcnt(12)
    s_branch K1_LWD
K1_LW9:
    s_waitcnt vmcnt(3)
K1_LWD:
    s_waitcnt lgkmcnt(0)
    s_barrier
    s_cmp_lg_u32 s32, 1
    s_cbranch_scc1 K1_LNS
    s_lshl_b32 s58, s31, 8
    s_add_u32 s58, s58, 140800
    v_lshl_add_u32 v9, v1, 2, s58
    s_cmp_eq_u32 s31, 3
    s_cselect_b32 exec_hi, 0, -1
    ds_write_b32 v9, v16
    s_mov_b32 exec_hi, -1
K1_LNS:
    s_cmp_ge_u32 s32, 8
    s_cbranch_scc1 K1_LND
    s_cmp_ge_u32 s29, 12
    s_cbranch_scc1 K1_DO_l
    ds_read_b128 v[48:51], v40
    ds_read_b128 v[52:55], v41
    ds_read_b128 v[56:59], v42
    ds_read_b128 v[60:63], v43
    s_add_u32 s70, s70, 1
    s_cmp_eq_u32 s70, 10
    s_cselect_b32 s70, 0, s70
    s_mov_b32 s71, 128
    s_cselect_b32 s71, 4294966144, s71
    s_mul_i32 s86, s68, -9
    s_cselect_b32 s86, s86, s68
    s_mov_b32 s87, 196608
    s_cselect_b32 s87, 4293197824, s87
    s_lshl_b32 s58, s31, 12
    s_add_u32 s58, s58, s33
    s_waitcnt lgkmcnt(3)
    v_lshlrev_b32 v64, 16, v48
    v_and_b32 v65, 0xffff0000, v48
    v_add_f32 v44, v44, v64
    v_add_f32 v45, v45, v65
    v_fma_f32 v46, v64, v64, v46
    v_fma_f32 v47, v65, v65, v47
    s_add_u32 m0, s58, 0
    s_nop 0
    buffer_load_dwordx4 v7, s[8:11], s36 offen lds
    v_lshlrev_b32 v66, 16, v49
    v_and_b32 v67, 0xffff0000, v49
    v_add_f32 v44, v44, v66
    v_add_f32 v45, v45, v67
    v_fma_f32 v46, v66, v66, v46
    v_fma_f32 v47, v67, v67, v47
    s_add_u32 m0, s58, 1024
    s_add_u32 s36, s36, s71
    buffer_load_dwordx4 v8, s[8:11], s37 offen lds
    v_lshlrev_b32 v64, 16, v50
    v_and_b32 v65, 0xffff0000, v50
    v_add_f32 v44, v44, v64
    v_add_f32 v45, v45, v65
    v_fma_f32 v46, v64, v64, v46
    v_fma_f32 v47, v65, v65, v47
    v_lshlrev_b32 v66, 16, v51
    v_and_b32 v67, 0xffff0000, v51
    v_add_f32 v44, v44, v66
    v_add_f32 v45, v45, v67
    v_fma_f32 v46, v66, v66, v46
    v_fma_f32 v47, v67, v67, v47
    s_add_u32 m0, s58, 2048
    s_add_u32 s37, s37, s71
    buffer_load_dwordx4 v7, s[8:11], s38 offen lds
    s_waitcnt lgkmcnt(2)
    v_lshlrev_b32 v64, 16, v52
    v_and_b32 v65, 0xffff0000, v52
    v_add_f32 v44, v44, v64
    v_add_f32 v45, v45, v65
    v_fma_f32 v46, v64, v64, v46
    v_fma_f32 v47, v65, v65, v47
    s_add_u32 m0, s58, 3072
    s_add_u32 s38, s38, s71
    buffer_load_dwordx4 v8, s[8:11], s39 offen lds
    s_add_u32 s39, s39, s71
    v_lshlrev_b32 v66, 16, v53
    v_and_b32 v67, 0xffff0000, v53
    v_add_f32 v44, v44, v66
    v_add_f32 v45, v45, v67
    v_fma_f32 v46, v66, v66, v46
    v_fma_f32 v47, v67, v67, v47
    s_mul_i32 s58, s31, 5120
    s_add_u32 s58, s58, s33
    s_lshl_b32 s59, s31, 11
    s_add_u32 s59, s59, s33
    s_add_u32 m0, s58, 16384
    s_nop 0
    buffer_load_dwordx4 v20, s[12:15], s40 offen lds
    v_lshlrev_b32 v64, 16, v54
    v_and_b32 v65, 0xffff0000, v54
    v_add_f32 v44, v44, v64
    v_add_f32 v45, v45, v65
    v_fma_f32 v46, v64, v64, v46
    v_fma_f32 v47, v65, v65, v47
    v_lshlrev_b32 v66, 16, v55
    v_and_b32 v67, 0xffff0000, v55
    v_add_f32 v44, v44, v66
    v_add_f32 v45, v45, v67
    v_fma_f32 v46, v66, v66, v46
    v_fma_f32 v47, v67, v67, v47
    s_add_u32 m0, s58, 17408
    s_nop 0
    buffer_load_dwordx4 v21, s[12:15], s40 offen lds
    s_waitcnt lgkmcnt(1)
    v_lshlrev_b32 v64, 16, v56
    v_and_b32 v65, 0xffff0000, v56
    v_add_f32 v44, v44, v64
    v_add_f32 v45, v45, v65
    v_fma_f32 v46, v64, v64, v46
    v_fma_f32 v47, v65, v65, v47
    s_add_u32 m0, s58, 18432
    s_nop 0
    buffer_load_dwordx4 v22, s[12:15], s40 offen lds
    v_lshlrev_b32 v66, 16, v57
    v_and_b32 v67, 0xffff0000, v57
    v_add_f32 v44, v44, v66
    v_add_f32 v45, v45, v67
    v_fma_f32 v46, v66, v66, v46
    v_fma_f32 v47, v67, v67, v47
    s_add_u32 m0, s58, 19456
    s_nop 0
    buffer_load_dwordx4 v23, s[12:15], s40 offen lds
    v_lshlrev_b32 v64, 16, v58
    v_and_b32 v65, 0xffff0000, v58
    v_add_f32 v44, v44, v64
    v_add_f32 v45, v45, v65
    v_fma_f32 v46, v64, v64, v46
    v_fma_f32 v47, v65, v65, v47
    v_lshlrev_b32 v66, 16, v59
    v_and_b32 v67, 0xffff0000, v59
    v_add_f32 v44, v44, v66
    v_add_f32 v45, v45, v67
    v_fma_f32 v46, v66, v66, v46
    v_fma_f32 v47, v67, v67, v47
    s_add_u32 m0, s58, 20480
    s_nop 0
    buffer_load_dwordx4 v24, s[12:15], s40 offen lds
    s_add_u32 s40, s40, s86
    s_waitcnt lgkmcnt(0)
    v_lshlrev_b32 v64, 16, v60
    v_and_b32 v65, 0xffff0000, v60
    v_add_f32 v44, v44, v64
    v_add_f32 v45, v45, v65
    v_fma_f32 v46, v64, v64, v46
    v_fma_f32 v47, v65, v65, v47
    s_add_u32 m0, s59, 36864
    s_nop 0
    buffer_load_dwordx4 v25, s[16:19], s45 offen lds
    s_add_u32 s45, s45, s87
    v_lshlrev_b32 v66, 16, v61
    v_and_b32 v67, 0xffff0000, v61
    v_add_f32 v44, v44, v66
    v_add_f32 v45, v45, v67
    v_fma_f32 v46, v66, v66, v46
    v_fma_f32 v47, v67, v67, v47
    s_add_u32 m0, s59, 37888
    s_nop 0
    buffer_load_dwordx4 v25, s[16:19], s46 offen lds
    s_add_u32 s46, s46, s87
    s_add_u32 s33, s33, 45056
    s_cmp_eq_u32 s33, 135168
    s_cselect_b32 s33, 0, s33
    v_lshlrev_b32 v64, 16, v62
    v_and_b32 v65, 0xffff0000, v62
    v_add_f32 v44, v44, v64
    v_add_f32 v45, v45, v65
    v_fma_f32 v46, v64, v64, v46
    v_fma_f32 v47, v65, v65, v47
    v_lshlrev_b32 v66, 16, v63
    v_and_b32 v67, 0xffff0000, v63
    v_add_f32 v44, v44, v66
    v_add_f32 v45, v45, v67
    v_fma_f32 v46, v66, v66, v46
    v_fma_f32 v47, v67, v67, v47
    s_branch K1_DE_l
K1_DO_l:
    ds_read_b128 v[48:51], v40
    ds_read_b128 v[52:55], v41
    ds_read_b128 v[56:59], v42
    ds_read_b128 v[60:63], v43
    s_add_u32 s70, s70, 1
    s_cmp_eq_u32 s70, 10
    s_cselect_b32 s70, 0, s70
    s_mov_b32 s71, 128
    s_cselect_b32 s71, 4294966144, s71
    s_mul_i32 s86, s68, -9
    s_cselect_b32 s86, s86, s68
    s_mov_b32 s87, 196608
    s_cselect_b32 s87, 4293197824, s87
    s_lshl_b32 s58, s31, 12
    s_add_u32 s58, s58, s33
    s_waitcnt lgkmcnt(3)
    v_lshlrev_b32 v64, 16, v48
    v_and_b32 v65, 0xffff0000, v48
    v_add_f32 v44, v44, v64
    v_add_f32 v45, v45, v65
    v_fma_f32 v46, v64, v64, v46
    v_fma_f32 v47, v65, v65, v47
    s_add_u32 m0, s58, 0
    s_nop 0
    buffer_load_dwordx4 v7, s[8:11], s36 offen lds
    v_lshlrev_b32 v66, 16, v49
    v_and_b32 v67, 0xffff0000, v49
    v_add_f32 v44, v44, v66
    v_add_f32 v45, v45, v67
    v_fma_f32 v46, v66, v66, v46
    v_fma_f32 v47, v67, v67, v47
    s_add_u32 m0, s58, 1024
    s_add_u32 s36, s36, s71
    buffer_load_dwordx4 v8, s[8:11], s37 offen lds
    v_lshlrev_b32 v64, 16, v50
    v_and_b32 v65, 0xffff0000, v50
    v_add_f32 v44, v44, v64
    v_add_f32 v45, v45, v65
    v_fma_f32 v46, v64, v64, v46
    v_fma_f32 v47, v65, v65, v47
    v_lshlrev_b32 v66, 16, v51
    v_and_b32 v67, 0xffff0000, v51
    v_add_f32 v44, v44, v66
    v_add_f32 v45, v45, v67
    v_fma_f32 v46, v66, v66, v46
    v_fma_f32 v47, v67, v67, v47
    s_add_u32 m0, s58, 2048
    s_add_u32 s37, s37, s71
    buffer_load_dwordx4 v7, s[8:11], s38 offen lds
    s_waitcnt lgkmcnt(2)
    v_lshlrev_b32 v64, 16, v52
    v_and_b32 v65, 0xffff0000, v52
    v_add_f32 v44, v44, v64
    v_add_f32 v45, v45, v65
    v_fma_f32 v46, v64, v64, v46
    v_fma_f32 v47, v65, v65, v47
    s_add_u32 m0, s58, 3072
    s_add_u32 s38, s38, s71
    buffer_load_dwordx4 v8, s[8:11], s39 offen lds
    s_add_u32 s39, s39, s71
    v_lshlrev_b32 v66, 16, v53
    v_and_b32 v67, 0xffff0000, v53
    v_add_f32 v44, v44, v66
    v_add_f32 v45, v45, v67
    v_fma_f32 v46, v66, v66, v46
    v_fma_f32 v47, v67, v67, v47
    s_lshl_b32 s58, s31, 10
    s_add_u32 s58, s58, s33
    s_add_u32 m0, s58, 16384
    s_nop 0
    buffer_load_dwordx4 v15, s[12:15], s40 offen lds
    s_add_u32 s40, s40, s86
    v_lshlrev_b32 v64, 16, v54
    v_and_b32 v65, 0xffff0000, v54
    v_add_f32 v44, v44, v64
    v_add_f32 v45, v45, v65
    v_fma_f32 v46, v64, v64, v46
    v_fma_f32 v47, v65, v65, v47
    v_lshlrev_b32 v66, 16, v55
    v_and_b32 v67, 0xffff0000, v55
    v_add_f32 v44, v44, v66
    v_add_f32 v45, v45, v67
    v_fma_f32 v46, v66, v66, v46
    v_fma_f32 v47, v67, v67, v47
    s_add_u32 m0, s58, 20480
    s_nop 0
    buffer_load_dwordx4 v15, s[12:15], s41 offen lds
    s_add_u32 s41, s41, s86
    s_waitcnt lgkmcnt(1)
    v_lshlrev_b32 v64, 16, v56
    v_and_b32 v65, 0xffff0000, v56
    v_add_f32 v44, v44, v64
    v_add_f32 v45, v45, v65
    v_fma_f32 v46, v64, v64, v46
    v_fma_f32 v47, v65, v65, v47
    s_add_u32 m0, s58, 24576
    s_nop 0
    buffer_load_dwordx4 v15, s[12:15], s42 offen lds
    s_add_u32 s42, s42, s86
    v_lshlrev_b32 v66, 16, v57
    v_and_b32 v67, 0xffff0000, v57
    v_add_f32 v44, v44, v66
    v_add_f32 v45, v45, v67
    v_fma_f32 v46, v66, v66, v46
    v_fma_f32 v47, v67, v67, v47
    s_add_u32 m0, s58, 28672
    s_nop 0
    buffer_load_dwordx4 v15, s[12:15], s43 offen lds
    s_add_u32 s43, s43, s86
    v_lshlrev_b32 v64, 16, v58
    v_and_b32 v65, 0xffff0000, v58
    v_add_f32 v44, v44, v64
    v_add_f32 v45, v45, v65
    v_fma_f32 v46, v64, v64, v46
    v_fma_f32 v47, v65, v65, v47
    v_lshlrev_b32 v66, 16, v59
    v_and_b32 v67, 0xffff0000, v59
    v_add_f32 v44, v44, v66
    v_add_f32 v45, v45, v67
    v_fma_f32 v46, v66, v66, v46
    v_fma_f32 v47, v67, v67, v47
    s_add_u32 m0, s58, 32768
    s_nop 0
    buffer_load_dwordx4 v15, s[12:15], s44 offen lds
    s_add_u32 s44, s44, s86
    s_waitcnt lgkmcnt(0)
    v_lshlrev_b32 v64, 16, v60
    v_and_b32 v65, 0xffff0000, v60
    v_add_f32 v44, v44, v64
    v_add_f32 v45, v45, v65
    v_fma_f32 v46, v64, v64, v46
    v_fma_f32 v47, v65, v65, v47
    s_add_u32 m0, s58, 36864
    s_nop 0
    buffer_load_dwordx4 v6, s[16:19], s45 offen lds
    s_add_u32 s45, s45, s87
    v_lshlrev_b32 v66, 16, v61
    v_and_b32 v67, 0xffff0000, v61
    v_add_f32 v44, v44, v66
    v_add_f32 v45, v45, v67
    v_fma_f32 v46, v66, v66, v46
    v_fma_f32 v47, v67, v67, v47
    s_add_u32 m0, s58, 40960
    s_nop 0
    buffer_load_dwordx4 v6, s[16:19], s46 offen lds
    s_add_u32 s46, s46, s87
    s_add_u32 s33, s33, 45056
    s_cmp_eq_u32 s33, 135168
    s_cselect_b32 s33, 0, s33
    v_lshlrev_b32 v64, 16, v62
    v_and_b32 v65, 0xffff0000, v62
    v_add_f32 v44, v44, v64
    v_add_f32 v45, v45, v65
    v_fma_f32 v46, v64, v64, v46
    v_fma_f32 v47, v65, v65, v47
    v_lshlrev_b32 v66, 16, v63
    v_and_b32 v67, 0xffff0000, v63
    v_add_f32 v44, v44, v66
    v_add_f32 v45, v45, v67
    v_fma_f32 v46, v66, v66, v46
    v_fma_f32 v47, v67, v67, v47
K1_DE_l:
    s_branch K1_LNX
K1_LND:
    ds_read_b128 v[48:51], v40
    ds_read_b128 v[52:55], v41
    ds_read_b128 v[56:59], v42
    ds_read_b128 v[60:63], v43
    s_waitcnt lgkmcnt(3)
    v_lshlrev_b32 v64, 16, v48
    v_and_b32 v65, 0xffff0000, v48
    v_add_f32 v44, v44, v64
    v_add_f32 v45, v45, v65
    v_fma_f32 v46, v64, v64, v46
    v_fma_f32 v47, v65, v65, v47
    v_lshlrev_b32 v66, 16, v49
    v_and_b32 v67, 0xffff0000, v49
    v_add_f32 v44, v44, v66
    v_add_f32 v45, v45, v67
    v_fma_f32 v46, v66, v66, v46
    v_fma_f32 v47, v67, v67, v47
    v_lshlrev_b32 v64, 16, v50
    v_and_b32 v65, 0xffff0000, v50
    v_add_f32 v44, v44, v64
    v_add_f32 v45, v45, v65
    v_fma_f32 v46, v64, v64, v46
    v_fma_f32 v47, v65, v65, v47
    v_lshlrev_b32 v66, 16, v51
    v_and_b32 v67, 0xffff0000, v51
    v_add_f32 v44, v44, v66
    v_add_f32 v45, v45, v67
    v_fma_f32 v46, v66, v66, v46
    v_fma_f32 v47, v67, v67, v47
    s_waitcnt lgkmcnt(2)
    v_lshlrev_b32 v64, 16, v52
    v_and_b32 v65, 0xffff0000, v52
    v_add_f32 v44, v44, v64
    v_add_f32 v45, v45, v65
    v_fma_f32 v46, v64, v64, v46
    v_fma_f32 v47, v65, v65, v47
    v_lshlrev_b32 v66, 16, v53
    v_and_b32 v67, 0xffff0000, v53
    v_add_f32 v44, v44, v66
    v_add_f32 v45, v45, v67
    v_fma_f32 v46, v66, v66, v46
    v_fma_f32 v47, v67, v67, v47
    v_lshlrev_b32 v64, 16, v54
    v_and_b32 v65, 0xffff0000, v54
    v_add_f32 v44, v44, v64
    v_add_f32 v45, v45, v65
    v_fma_f32 v46, v64, v64, v46
    v_fma_f32 v47, v65, v65, v47
    v_lshlrev_b32 v66, 16, v55
    v_and_b32 v67, 0xffff0000, v55
    v_add_f32 v44, v44, v66
    v_add_f32 v45, v45, v67
    v_fma_f32 v46, v66, v66, v46
    v_fma_f32 v47, v67, v67, v47
    s_waitcnt lgkmcnt(1)
    v_lshlrev_b32 v64, 16, v56
    v_and_b32 v65, 0xffff0000, v56
    v_add_f32 v44, v44, v64
    v_add_f32 v45, v45, v65
    v_fma_f32 v46, v64, v64, v46
    v_fma_f32 v47, v65, v65, v47
    v_lshlrev_b32 v66, 16, v57
    v_and_b32 v67, 0xffff0000, v57
    v_add_f32 v44, v44, v66
    v_add_f32 v45, v45, v67
    v_fma_f32 v46, v66, v66, v46
    v_fma_f32 v47, v67, v67, v47
    v_lshlrev_b32 v64, 16, v58
    v_and_b32 v65, 0xffff0000, v58
    v_add_f32 v44, v44, v64
    v_add_f32 v45, v45, v65
    v_fma_f32 v46, v64, v64, v46
    v_fma_f32 v47, v65, v65, v47
    v_lshlrev_b32 v66, 16, v59
    v_and_b32 v67, 0xffff0000, v59
    v_add_f32 v44, v44, v66
    v_add_f32 v45, v45, v67
    v_fma_f32 v46, v66, v66, v46
    v_fma_f32 v47, v67, v67, v47
    s_waitcnt lgkmcnt(0)
    v_lshlrev_b32 v64, 16, v60
    v_and_b32 v65, 0xffff0000, v60
    v_add_f32 v44, v44, v64
    v_add_f32 v45, v45, v65
    v_fma_f32 v46, v64, v64, v46
    v_fma_f32 v47, v65, v65, v47
    v_lshlrev_b32 v66, 16, v61
    v_and_b32 v67, 0xffff0000, v61
    v_add_f32 v44, v44, v66
    v_add_f32 v45, v45, v67
    v_fma_f32 v46, v66, v66, v46
    v_fma_f32 v47, v67, v67, v47
    v_lshlrev_b32 v64, 16, v62
    v_and_b32 v65, 0xffff0000, v62
    v_add_f32 v44, v44, v64
    v_add_f32 v45, v45, v65
    v_fma_f32 v46, v64, v64, v46
    v_fma_f32 v47, v65, v65, v47
    v_lshlrev_b32 v66, 16, v63
    v_and_b32 v67, 0xffff0000, v63
    v_add_f32 v44, v44, v66
    v_add_f32 v45, v45, v67
    v_fma_f32 v46, v66, v66, v46
    v_fma_f32 v47, v67, v67, v47
    s_cmp_lg_u32 s32, 8
    s_cbranch_scc1 K1_LNX
    v_lshrrev_b32 v9, 2, v1
    v_bfe_u32 v13, v9, 2, 1
    v_lshrrev_b32 v14, 3, v9
    v_and_b32 v9, 3, v9
    v_lshl_add_u32 v10, v13, 3, v9
    v_lshl_add_u32 v10, v14, 2, v10
    v_mul_u32_u24 v10, 1280, v10
    v_lshl_add_u32 v11, v14, 1, v13
    v_mul_u32_u24 v11, 20, v11
    v_add_u32 v11, v11, v9
    v_mul_u32_u24 v11, 1280, v11
    v_and_b32 v9, 3, v1
    v_lshlrev_b32 v9, 4, v9
    v_add_u32 v10, v10, v9
    v_add_u32 v11, v11, v9
    v_lshrrev_b32 v9, 5, v1
    v_lshlrev_b32 v9, 9, v9
    v_bfe_u32 v13, v1, 2, 2
    v_lshl_add_u32 v9, v13, 6, v9
    v_bfe_u32 v13, v1, 4, 1
    v_lshl_add_u32 v9, v13, 5, v9
    v_and_b32 v13, 3, v1
    v_lshl_add_u32 v12, v13, 3, v9
    s_lshl_b32 s56, s2, 2
    s_add_u32 s56, s56, s31
    s_add_u32 s58, s56, 0
    s_mul_i32 s59, s31, 3072
    s_add_u32 m0, s59, 141824
    s_cmp_ge_u32 s58, 1920
    s_cbranch_scc1 K1_SIDE_WO0
    s_mul_i32 s59, s58, 43691
    s_lshr_b32 s59, s59, 22
    s_mul_i32 s4, s59, 96
    s_sub_u32 s4, s58, s4
    s_mul_i32 s4, s4, 20480
    s_lshl_b32 s59, s59, 6
    s_add_u32 s4, s4, s59
    s_mov_b32 s24, s62
    s_and_b32 s25, s63, 0xffff
    s_mov_b32 s26, 1966080
    s_mov_b32 s27, 0x00020000
    buffer_load_dwordx4 v10, s[24:27], s4 offen lds
    s_branch K1_SIDE_SKIP0
K1_SIDE_WO0:
    s_sub_u32 s58, s58, 1920
    s_mul_i32 s59, s58, 52429
    s_lshr_b32 s59, s59, 21
    s_mul_i32 s4, s59, 40
    s_sub_u32 s4, s58, s4
    s_mul_i32 s5, s4, 52429
    s_lshr_b32 s5, s5, 18
    s_mul_i32 s6, s5, 5
    s_sub_u32 s6, s4, s6
    s_lshl_b32 s59, s59, 6
    s_mov_b32 s24, s60
    s_and_b32 s25, s61, 0xffff
    s_mov_b32 s26, 819200
    s_mov_b32 s27, 0x00020000
    s_cmp_eq_u32 s6, 4
    s_cbranch_scc1 K1_SIDE_WOT0
    s_lshl_b32 s5, s5, 2
    s_add_u32 s5, s5, s6
    s_mul_i32 s5, s5, 25600
    s_add_u32 s5, s5, s59
    buffer_load_dwordx4 v10, s[24:27], s5 offen lds
    s_branch K1_SIDE_SKIP0
K1_SIDE_WOT0:
    s_mul_i32 s5, s5, 102400
    s_add_u32 s5, s5, 20480
    s_add_u32 s5, s5, s59
    buffer_load_dwordx4 v11, s[24:27], s5 offen lds
K1_SIDE_SKIP0:
    s_add_u32 s58, s56, 1024
    s_mul_i32 s59, s31, 3072
    s_add_u32 m0, s59, 142848
    s_cmp_ge_u32 s58, 1920
    s_cbranch_scc1 K1_SIDE_WO1
    s_mul_i32 s59, s58, 43691
    s_lshr_b32 s59, s59, 22
    s_mul_i32 s4, s59, 96
    s_sub_u32 s4, s58, s4
    s_mul_i32 s4, s4, 20480
    s_lshl_b32 s59, s59, 6
    s_add_u32 s4, s4, s59
    s_mov_b32 s24, s62
    s_and_b32 s25, s63, 0xffff
    s_mov_b32 s26, 1966080
    s_mov_b32 s27, 0x00020000
    buffer_load_dwordx4 v10, s[24:27], s4 offen lds
    s_branch K1_SIDE_SKIP1
K1_SIDE_WO1:
    s_sub_u32 s58, s58, 1920
    s_mul_i32 s59, s58, 52429
    s_lshr_b32 s59, s59, 21
    s_mul_i32 s4, s59, 40
    s_sub_u32 s4, s58, s4
    s_mul_i32 s5, s4, 52429
    s_lshr_b32 s5, s5, 18
    s_mul_i32 s6, s5, 5
    s_sub_u32 s6, s4, s6
    s_lshl_b32 s59, s59, 6
    s_mov_b32 s24, s60
    s_and_b32 s25, s61, 0xffff
    s_mov_b32 s26, 819200
    s_mov_b32 s27, 0x00020000
    s_cmp_eq_u32 s6, 4
    s_cbranch_scc1 K1_SIDE_WOT1
    s_lshl_b32 s5, s5, 2
    s_add_u32 s5, s5, s6
    s_mul_i32 s5, s5, 25600
    s_add_u32 s5, s5, s59
    buffer_load_dwordx4 v10, s[24:27], s5 offen lds
    s_branch K1_SIDE_SKIP1
K1_SIDE_WOT1:
    s_mul_i32 s5, s5, 102400
    s_add_u32 s5, s5, 20480
    s_add_u32 s5, s5, s59
    buffer_load_dwordx4 v11, s[24:27], s5 offen lds
K1_SIDE_SKIP1:
    s_add_u32 s58, s56, 2048
    s_mul_i32 s59, s31, 3072
    s_add_u32 m0, s59, 143872
    s_cmp_ge_u32 s58, 1920
    s_cbranch_scc1 K1_SIDE_WO2
    s_mul_i32 s59, s58, 43691
    s_lshr_b32 s59, s59, 22
    s_mul_i32 s4, s59, 96
    s_sub_u32 s4, s58, s4
    s_mul_i32 s4, s4, 20480
    s_lshl_b32 s59, s59, 6
    s_add_u32 s4, s4, s59
    s_mov_b32 s24, s62
    s_and_b32 s25, s63, 0xffff
    s_mov_b32 s26, 1966080
    s_mov_b32 s27, 0x00020000
    buffer_load_dwordx4 v10, s[24:27], s4 offen lds
    s_branch K1_SIDE_SKIP2
K1_SIDE_WO2:
    s_sub_u32 s58, s58, 1920
    s_mul_i32 s59, s58, 52429
    s_lshr_b32 s59, s59, 21
    s_mul_i32 s4, s59, 40
    s_sub_u32 s4, s58, s4
    s_mul_i32 s5, s4, 52429
    s_lshr_b32 s5, s5, 18
    s_mul_i32 s6, s5, 5
    s_sub_u32 s6, s4, s6
    s_lshl_b32 s59, s59, 6
    s_mov_b32 s24, s60
    s_and_b32 s25, s61, 0xffff
    s_mov_b32 s26, 819200
    s_mov_b32 s27, 0x00020000
    s_cmp_eq_u32 s6, 4
    s_cbranch_scc1 K1_SIDE_WOT2
    s_lshl_b32 s5, s5, 2
    s_add_u32 s5, s5, s6
    s_mul_i32 s5, s5, 25600
    s_add_u32 s5, s5, s59
    buffer_load_dwordx4 v10, s[24:27], s5 offen lds
    s_branch K1_SIDE_SKIP2
K1_SIDE_WOT2:
    s_mul_i32 s5, s5, 102400
    s_add_u32 s5, s5, 20480
    s_add_u32 s5, s5, s59
    buffer_load_dwordx4 v11, s[24:27], s5 offen lds
K1_SIDE_SKIP2:
K1_LNX:
    s_add_u32 s35, s35, 1
    s_cmp_eq_u32 s35, 3
    s_mov_b32 s34, 45056
    s_cselect_b32 s34, 4294877184, s34
    s_cselect_b32 s35, 0, s35
    v_add_u32 v40, s34, v40
    v_add_u32 v41, s34, v41
    v_add_u32 v42, s34, v42
    v_add_u32 v43, s34, v43
    s_add_u32 s32, s32, 1
    s_cmp_lt_u32 s32, 10
    s_cbranch_scc1 K1_LLOOP
    v_add_f32 v44, v44, v45
    v_add_f32 v46, v46, v47
    v_mov_b32 v64, v44
    v_mov_b32 v65, v46
    s_nop 1
    v_permlane32_swap_b32 v64, v44
    v_permlane32_swap_b32 v65, v46
    s_lshl_b32 s58, s31, 8
    s_add_u32 s58, s58, 135168
    v_add_f32 v44, v44, v64
    v_add_f32 v45, v46, v65
    v_lshl_add_u32 v64, v2, 3, s58
    v_mov_b32 v46, 0
    v_mov_b32 v47, 0
    ds_write_b64 v64, v[44:45]
    ds_write_b64 v64, v[46:47] offset:1024
    s_waitcnt lgkmcnt(0)
    s_barrier
    s_waitcnt vmcnt(0)
    s_add_u32 s58, s56, 0
    s_cmp_ge_u32 s58, 2720
    s_cbranch_scc1 K1_SFE
    s_mul_i32 s59, s31, 3072
    s_add_u32 s59, s59, 141824
    v_add_u32 v9, s59, v12
    ds_read_b64_tr_b16 v[28:29], v9
    ds_read_b64_tr_b16 v[30:31], v9 offset:256
    s_lshl_b32 s58, s58, 10
    s_add_u32 s58, s58, 16777216
    s_waitcnt lgkmcnt(0)
    buffer_store_dwordx4 v[28:31], v4, s[20:23], s58 offen sc0 sc1
    s_nop 1
    s_add_u32 s58, s56, 1024
    s_cmp_ge_u32 s58, 2720
    s_cbranch_scc1 K1_SFE
    s_mul_i32 s59, s31, 3072
    s_add_u32 s59, s59, 142848
    v_add_u32 v9, s59, v12
    ds_read_b64_tr_b16 v[28:29], v9
    ds_read_b64_tr_b16 v[30:31], v9 offset:256
    s_lshl_b32 s58, s58, 10
    s_add_u32 s58, s58, 16777216
    s_waitcnt lgkmcnt(0)
    buffer_store_dwordx4 v[28:31], v4, s[20:23], s58 offen sc0 sc1
    s_nop 1
    s_add_u32 s58, s56, 2048
    s_cmp_ge_u32 s58, 2720
    s_cbranch_scc1 K1_SFE
    s_mul_i32 s59, s31, 3072
    s_add_u32 s59, s59, 143872
    v_add_u32 v9, s59, v12
    ds_read_b64_tr_b16 v[28:29], v9
    ds_read_b64_tr_b16 v[30:31], v9 offset:256
    s_lshl_b32 s58, s58, 10
    s_add_u32 s58, s58, 16777216
    s_waitcnt lgkmcnt(0)
    buffer_store_dwordx4 v[28:31], v4, s[20:23], s58 offen sc0 sc1
    s_nop 1
K1_SFE:
    v_mov_b32 v28, -1
    v_mov_b32 v29, -1
    v_mov_b32 v30, -1
    v_mov_b32 v31, -1
    s_mul_i32 s58, s2, 10240
    s_lshl_b32 s59, s31, 10
    s_add_u32 s58, s58, s59
    s_add_u32 s58, s58, 14155776
    buffer_store_dwordx4 v[28:31], v4, s[20:23], s58 offen sc0 sc1
    s_add_u32 s58, s58, 4096
    buffer_store_dwordx4 v[28:31], v4, s[20:23], s58 offen sc0 sc1
    s_cmp_ge_u32 s31, 2
    s_cbranch_scc1 K1_SF2
    s_add_u32 s58, s58, 4096
    buffer_store_dwordx4 v[28:31], v4, s[20:23], s58 offen sc0 sc1
K1_SF2:
K1_END:
    s_endpgm
K1_TEXT_END:
.section .rodata,"a"
.p2align 6
.amdhsa_kernel k1_kernel
  .amdhsa_next_free_vgpr 168
  .amdhsa_next_free_sgpr 96
  .amdhsa_accum_offset 168
  .amdhsa_group_segment_fixed_size 0
  .amdhsa_kernarg_size 88
  .amdhsa_user_sgpr_count 2
  .amdhsa_user_sgpr_kernarg_segment_ptr 1
  .amdhsa_system_sgpr_workgroup_id_x 1
.end_amdhsa_kernel
.text
.globl k2_kernel
.p2align 8
.type k2_kernel,@function
k2_kernel:
    s_cmp_ge_u32 s2, 256
    s_cbranch_scc1 K2_END
    s_load_dwordx2 s[4:5], s[0:1], 80
    v_and_b32 v1, 63, v0
    v_lshrrev_b32 v2, 6, v0
    s_and_b32 s12, s2, 7
    v_readfirstlane_b32 s14, v2
    s_nop 1
    s_cmp_ge_u32 s14, 8
    s_cbranch_scc1 K2_GEMM
    s_lshl_b32 s12, s12, 2
    s_lshr_b32 s13, s2, 6
    s_add_u32 s12, s12, s13
    s_lshr_b32 s13, s2, 3
    s_and_b32 s13, s13, 7
    v_and_b32 v5, 31, v1
    v_lshrrev_b32 v6, 5, v1
    v_lshlrev_b32 v7, 4, v1
    v_mul_u32_u24 v2, 40, v5
    v_add_u32 v3, 32, v2
    v_lshl_add_u32 v2, v6, 4, v2
    v_mul_u32_u24 v4, 320, v6
    v_lshl_add_u32 v4, v5, 4, v4
    v_add_u32 v4, 1280, v4
    s_mov_b32 s16, 0x000fffff
    s_mov_b32 s17, 0x000fffff
    v_mov_b32 v12, 0
    v_mov_b32 v13, 0
    s_waitcnt lgkmcnt(0)
    s_mov_b32 s8, s4
    s_and_b32 s9, s5, 0xffff
    s_mov_b32 s10, 33554432
    s_mov_b32 s11, 0x00020000
    s_mul_i32 s19, s12, 81920
    s_lshl_b32 s24, s13, 8
    s_lshl_b32 s25, s14, 5
    s_add_u32 s24, s24, s25
    s_mul_i32 s25, s24, 40
    s_add_u32 s19, s19, s25
    s_add_u32 s19, s19, 0
    buffer_load_dwordx4 v[8:11], v2, s[8:11], s19 offen
    s_mov_b32 exec_hi, 0
    buffer_load_dwordx2 v[12:13], v3, s[8:11], s19 offen
    s_mov_b32 exec_hi, -1
    s_mul_i32 s19, s12, 163840
    s_lshl_b32 s25, s14, 10
    s_add_u32 s19, s19, s25
    s_mov_b32 m0, s25
    s_add_u32 s19, s19, 2621440
    buffer_load_dwordx4 v7, s[8:11], s19 offen lds
    s_add_u32 m0, m0, 8192
    s_add_u32 s19, s19, 8192
    buffer_load_dwordx4 v7, s[8:11], s19 offen lds
    s_add_u32 m0, m0, 8192
    s_add_u32 s19, s19, 8192
    buffer_load_dwordx4 v7, s[8:11], s19 offen lds
    s_add_u32 m0, m0, 8192
    s_add_u32 s19, s19, 8192
    buffer_load_dwordx4 v7, s[8:11], s19 offen lds
    v_cmp_eq_u32 vcc, 20, v5
    v_mov_b32 v112, 0x3f803f80
    s_nop 0
    v_cndmask_b32 v24, 0, v112, vcc
    v_mov_b32 v25, v24
    v_mov_b32 v26, v24
    v_mov_b32 v27, v24
    v_mov_b32 v28, v24
    v_mov_b32 v29, v24
    v_mov_b32 v30, v24
    v_mov_b32 v31, v24
    v_mov_b32 v32, v24
    v_mov_b32 v33, v24
    v_mov_b32 v34, v24
    v_mov_b32 v35, v24
    v_mov_b32 v36, v24
    v_mov_b32 v37, v24
    v_mov_b32 v38, v24
    v_mov_b32 v39, v24
    v_lshl_add_u32 v3, v6, 18, v3
    s_mov_b32 s20, 0
    s_mov_b32 s21, 1
    s_mov_b32 s22, 0xc2a80000
    s_waitcnt vmcnt(0)
    s_barrier
K2_SAMPLE:
    v_mov_b32 v112, v2
    v_mov_b32 v113, v3
    v_mov_b32 v114, 0xff800000
    s_mov_b32 s18, s21
    ds_read_b64 v[16:17], v112
    ds_read_b64 v[18:19], v112 offset:8
    ds_read_b64 v[20:21], v113
    ds_read_b64 v[40:41], v112 offset:2560
    ds_read_b64 v[42:43], v112 offset:2568
    ds_read_b64 v[44:45], v113 offset:2560
K2_SLOOP:
    s_waitcnt lgkmcnt(0)
    v_mfma_f32_32x32x16_bf16 v[64:79], v[16:19], v[8:11], 0
    v_mfma_f32_32x32x16_bf16 v[80:95], v[40:43], v[8:11], 0
    v_mfma_f32_32x32x8_bf16 v[64:79], v[20:21], v[12:13], v[64:79]
    v_mfma_f32_32x32x8_bf16 v[80:95], v[44:45], v[12:13], v[80:95]
    v_add_u32 v112, 5120, v112
    v_add_u32 v113, 5120, v113
    ds_read_b64 v[16:17], v112
    ds_read_b64 v[18:19], v112 offset:8
    ds_read_b64 v[20:21], v113
    ds_read_b64 v[40:41], v112 offset:2560
    ds_read_b64 v[42:43], v112 offset:2568
    ds_read_b64 v[44:45], v113 offset:2560
    s_nop 4
    v_max3_f32 v114, v64, v65, v114
    v_max3_f32 v114, v66, v67, v114
    v_max3_f32 v114, v68, v69, v114
    v_max3_f32 v114, v70, v71, v114
    v_max3_f32 v114, v72, v73, v114
    v_max3_f32 v114, v74, v75, v114
    v_max3_f32 v114, v76, v77, v114
    v_max3_f32 v114, v78, v79, v114
    v_max3_f32 v114, v80, v81, v114
    v_max3_f32 v114, v82, v83, v114
    v_max3_f32 v114, v84, v85, v114
    v_max3_f32 v114, v86, v87, v114
    v_max3_f32 v114, v88, v89, v114
    v_max3_f32 v114, v90, v91, v114
    v_max3_f32 v114, v92, v93, v114
    v_max3_f32 v114, v94, v95, v114
    s_sub_u32 s18, s18, 1
    s_cmp_lg_u32 s18, 0
    s_cbranch_scc1 K2_SLOOP
    v_mov_b32 v112, v114
    s_waitcnt lgkmcnt(0)
    s_nop 0
    v_permlane32_swap_b32 v112, v114
    s_nop 1
    v_max_f32 v114, v114, v112
    v_sub_f32 v48, s22, v114
    v_mov_b32 v49, v48
    v_mov_b32 v50, v48
    v_mov_b32 v51, v48
    v_mov_b32 v52, v48
    v_mov_b32 v53, v48
    v_mov_b32 v54, v48
    v_mov_b32 v55, v48
    v_mov_b32 v56, v48
    v_mov_b32 v57, v48
    v_mov_b32 v58, v48
    v_mov_b32 v59, v48
    v_mov_b32 v60, v48
    v_mov_b32 v61, v48
    v_mov_b32 v62, v48
    v_mov_b32 v63, v48
    v_mov_b32 v96, 0
    v_mov_b32 v97, 0
    v_mov_b32 v98, 0
    v_mov_b32 v99, 0
    v_mov_b32 v100, 0
    v_mov_b32 v101, 0
    v_mov_b32 v102, 0
    v_mov_b32 v103, 0
    v_mov_b32 v104, 0
    v_mov_b32 v105, 0
    v_mov_b32 v106, 0
    v_mov_b32 v107, 0
    v_mov_b32 v108, 0
    v_mov_b32 v109, 0
    v_mov_b32 v110, 0
    v_mov_b32 v111, 0
    v_mov_b32 v44, 0
    v_mov_b32 v45, 0
    v_mov_b32 v46, 0
    v_mov_b32 v47, 0
    v_mov_b32 v116, v2
    v_mov_b32 v117, v3
    v_mov_b32 v118, v4
    ds_read_b64 v[16:17], v116
    ds_read_b64 v[18:19], v116 offset:8
    ds_read_b64 v[20:21], v117
    s_mov_b64 exec, s[16:17]
    ds_read_b128 v[24:27], v118
    ds_read_b128 v[28:31], v118 offset:640
    s_mov_b64 exec, -1
    s_waitcnt lgkmcnt(2)
    v_mfma_f32_32x32x16_bf16 v[64:79], v[16:19], v[8:11], v[48:63]
    v_mfma_f32_32x32x8_bf16 v[64:79], v[20:21], v[12:13], v[64:79]
    ds_read_b64 v[16:17], v116 offset:2560
    ds_read_b64 v[18:19], v116 offset:2568
    ds_read_b64 v[20:21], v117 offset:2560
    s_mov_b32 s18, 0
    s_nop 7
    s_setprio 1
    s_cmp_ge_u32 s14, 4
    s_cbranch_scc1 K2_PRIO_DONE
    s_setprio 2
K2_PRIO_DONE:
.p2align 6
K2_LOOP:
    s_waitcnt lgkmcnt(0)
    v_mfma_f32_32x32x16_bf16 v[80:95], v[16:19], v[8:11], v[48:63]
    v_exp_f32 v64, v64
    v_exp_f32 v65, v65
    v_mfma_f32_32x32x16_bf16 v[96:111], v[36:39], v[44:47], v[96:111]
    s_mov_b64 exec, s[16:17]
    ds_read_b128 v[32:35], v118 offset:2560
    ds_read_b128 v[36:39], v118 offset:3200
    s_mov_b64 exec, -1
    v_exp_f32 v66, v66
    v_exp_f32 v67, v67
    v_exp_f32 v68, v68
    v_cvt_pk_bf16_f32 v40, v64, v65
    v_mfma_f32_32x32x8_bf16 v[80:95], v[20:21], v[12:13], v[80:95]
    v_exp_f32 v69, v69
    v_cvt_pk_bf16_f32 v41, v66, v67
    ds_read_b64 v[16:17], v116 offset:5120
    ds_read_b64 v[18:19], v116 offset:5128
    ds_read_b64 v[20:21], v117 offset:5120
    v_exp_f32 v70, v70
    v_exp_f32 v71, v71
    v_cvt_pk_bf16_f32 v42, v68, v69
    v_exp_f32 v72, v72
    v_exp_f32 v73, v73
    v_cvt_pk_bf16_f32 v43, v70, v71
    v_exp_f32 v74, v74
    v_exp_f32 v75, v75
    v_mfma_f32_32x32x16_bf16 v[96:111], v[24:27], v[40:43], v[96:111]
    v_exp_f32 v76, v76
    v_cvt_pk_bf16_f32 v44, v72, v73
    v_exp_f32 v77, v77
    v_cvt_pk_bf16_f32 v45, v74, v75
    v_exp_f32 v78, v78
    v_exp_f32 v79, v79
    v_cvt_pk_bf16_f32 v46, v76, v77
    v_cvt_pk_bf16_f32 v47, v78, v79
    s_waitcnt lgkmcnt(0)
    v_mfma_f32_32x32x16_bf16 v[64:79], v[16:19], v[8:11], v[48:63]
    v_exp_f32 v80, v80
    v_exp_f32 v81, v81
    v_mfma_f32_32x32x16_bf16 v[96:111], v[28:31], v[44:47], v[96:111]
    s_mov_b64 exec, s[16:17]
    ds_read_b128 v[24:27], v118 offset:5120
    ds_read_b128 v[28:31], v118 offset:5760
    s_mov_b64 exec, -1
    v_exp_f32 v82, v82
    v_exp_f32 v83, v83
    v_exp_f32 v84, v84
    v_cvt_pk_bf16_f32 v40, v80, v81
    v_mfma_f32_32x32x8_bf16 v[64:79], v[20:21], v[12:13], v[64:79]
    v_exp_f32 v85, v85
    v_cvt_pk_bf16_f32 v41, v82, v83
    ds_read_b64 v[16:17], v116 offset:7680
    ds_read_b64 v[18:19], v116 offset:7688
    ds_read_b64 v[20:21], v117 offset:7680
    v_exp_f32 v86, v86
    v_exp_f32 v87, v87
    v_cvt_pk_bf16_f32 v42, v84, v85
    v_exp_f32 v88, v88
    v_exp_f32 v89, v89
    v_cvt_pk_bf16_f32 v43, v86, v87
    v_exp_f32 v90, v90
    v_exp_f32 v91, v91
    v_mfma_f32_32x32x16_bf16 v[96:111], v[32:35], v[40:43], v[96:111]
    v_exp_f32 v92, v92
    v_cvt_pk_bf16_f32 v44, v88, v89
    v_exp_f32 v93, v93
    v_cvt_pk_bf16_f32 v45, v90, v91
    v_exp_f32 v94, v94
    v_exp_f32 v95, v95
    v_cvt_pk_bf16_f32 v46, v92, v93
    v_cvt_pk_bf16_f32 v47, v94, v95
    s_waitcnt lgkmcnt(0)
    v_mfma_f32_32x32x16_bf16 v[80:95], v[16:19], v[8:11], v[48:63]
    v_exp_f32 v64, v64
    v_exp_f32 v65, v65
    v_mfma_f32_32x32x16_bf16 v[96:111], v[36:39], v[44:47], v[96:111]
    s_mov_b64 exec, s[16:17]
    ds_read_b128 v[32:35], v118 offset:7680
    ds_read_b128 v[36:39], v118 offset:8320
    s_mov_b64 exec, -1
    v_exp_f32 v66, v66
    v_exp_f32 v67, v67
    v_exp_f32 v68, v68
    v_cvt_pk_bf16_f32 v40, v64, v65
    v_mfma_f32_32x32x8_bf16 v[80:95], v[20:21], v[12:13], v[80:95]
    v_exp_f32 v69, v69
    v_cvt_pk_bf16_f32 v41, v66, v67
    ds_read_b64 v[16:17], v116 offset:10240
    ds_read_b64 v[18:19], v116 offset:10248
    ds_read_b64 v[20:21], v117 offset:10240
    v_exp_f32 v70, v70
    v_exp_f32 v71, v71
    v_cvt_pk_bf16_f32 v42, v68, v69
    v_exp_f32 v72, v72
    v_exp_f32 v73, v73
    v_cvt_pk_bf16_f32 v43, v70, v71
    v_exp_f32 v74, v74
    v_exp_f32 v75, v75
    v_mfma_f32_32x32x16_bf16 v[96:111], v[24:27], v[40:43], v[96:111]
    v_exp_f32 v76, v76
    v_cvt_pk_bf16_f32 v44, v72, v73
    v_exp_f32 v77, v77
    v_cvt_pk_bf16_f32 v45, v74, v75
    v_exp_f32 v78, v78
    v_exp_f32 v79, v79
    v_cvt_pk_bf16_f32 v46, v76, v77
    v_cvt_pk_bf16_f32 v47, v78, v79
    s_waitcnt lgkmcnt(0)
    v_mfma_f32_32x32x16_bf16 v[64:79], v[16:19], v[8:11], v[48:63]
    v_exp_f32 v80, v80
    v_exp_f32 v81, v81
    v_mfma_f32_32x32x16_bf16 v[96:111], v[28:31], v[44:47], v[96:111]
    s_mov_b64 exec, s[16:17]
    ds_read_b128 v[24:27], v118 offset:10240
    ds_read_b128 v[28:31], v118 offset:10880
    s_mov_b64 exec, -1
    v_exp_f32 v82, v82
    v_exp_f32 v83, v83
    v_exp_f32 v84, v84
    v_cvt_pk_bf16_f32 v40, v80, v81
    v_mfma_f32_32x32x8_bf16 v[64:79], v[20:21], v[12:13], v[64:79]
    v_exp_f32 v85, v85
    v_cvt_pk_bf16_f32 v41, v82, v83
    ds_read_b64 v[16:17], v116 offset:12800
    ds_read_b64 v[18:19], v116 offset:12808
    ds_read_b64 v[20:21], v117 offset:12800
    v_exp_f32 v86, v86
    v_exp_f32 v87, v87
    v_cvt_pk_bf16_f32 v42, v84, v85
    v_exp_f32 v88, v88
    v_exp_f32 v89, v89
    v_cvt_pk_bf16_f32 v43, v86, v87
    v_exp_f32 v90, v90
    v_exp_f32 v91, v91
    v_mfma_f32_32x32x16_bf16 v[96:111], v[32:35], v[40:43], v[96:111]
    v_exp_f32 v92, v92
    v_cvt_pk_bf16_f32 v44, v88, v89
    v_exp_f32 v93, v93
    v_cvt_pk_bf16_f32 v45, v90, v91
    v_exp_f32 v94, v94
    v_exp_f32 v95, v95
    v_cvt_pk_bf16_f32 v46, v92, v93
    v_cvt_pk_bf16_f32 v47, v94, v95
    s_waitcnt lgkmcnt(0)
    v_mfma_f32_32x32x16_bf16 v[80:95], v[16:19], v[8:11], v[48:63]
    v_exp_f32 v64, v64
    v_exp_f32 v65, v65
    v_mfma_f32_32x32x16_bf16 v[96:111], v[36:39], v[44:47], v[96:111]
    s_mov_b64 exec, s[16:17]
    ds_read_b128 v[32:35], v118 offset:12800
    ds_read_b128 v[36:39], v118 offset:13440
    s_mov_b64 exec, -1
    v_exp_f32 v66, v66
    v_exp_f32 v67, v67
    v_exp_f32 v68, v68
    v_cvt_pk_bf16_f32 v40, v64, v65
    v_mfma_f32_32x32x8_bf16 v[80:95], v[20:21], v[12:13], v[80:95]
    v_exp_f32 v69, v69
    v_cvt_pk_bf16_f32 v41, v66, v67
    ds_read_b64 v[16:17], v116 offset:15360
    ds_read_b64 v[18:19], v116 offset:15368
    ds_read_b64 v[20:21], v117 offset:15360
    v_exp_f32 v70, v70
    v_exp_f32 v71, v71
    v_cvt_pk_bf16_f32 v42, v68, v69
    v_exp_f32 v72, v72
    v_exp_f32 v73, v73
    v_cvt_pk_bf16_f32 v43, v70, v71
    v_exp_f32 v74, v74
    v_exp_f32 v75, v75
    v_mfma_f32_32x32x16_bf16 v[96:111], v[24:27], v[40:43], v[96:111]
    v_exp_f32 v76, v76
    v_cvt_pk_bf16_f32 v44, v72, v73
    v_exp_f32 v77, v77
    v_cvt_pk_bf16_f32 v45, v74, v75
    v_exp_f32 v78, v78
    v_exp_f32 v79, v79
    v_cvt_pk_bf16_f32 v46, v76, v77
    v_cvt_pk_bf16_f32 v47, v78, v79
    s_waitcnt lgkmcnt(0)
    v_mfma_f32_32x32x16_bf16 v[64:79], v[16:19], v[8:11], v[48:63]
    v_exp_f32 v80, v80
    v_exp_f32 v81, v81
    v_mfma_f32_32x32x16_bf16 v[96:111], v[28:31], v[44:47], v[96:111]
    s_mov_b64 exec, s[16:17]
    ds_read_b128 v[24:27], v118 offset:15360
    ds_read_b128 v[28:31], v118 offset:16000
    s_mov_b64 exec, -1
    v_exp_f32 v82, v82
    v_exp_f32 v83, v83
    v_exp_f32 v84, v84
    v_cvt_pk_bf16_f32 v40, v80, v81
    v_mfma_f32_32x32x8_bf16 v[64:79], v[20:21], v[12:13], v[64:79]
    v_exp_f32 v85, v85
    v_cvt_pk_bf16_f32 v41, v82, v83
    ds_read_b64 v[16:17], v116 offset:17920
    ds_read_b64 v[18:19], v116 offset:17928
    ds_read_b64 v[20:21], v117 offset:17920
    v_exp_f32 v86, v86
    v_exp_f32 v87, v87
    v_cvt_pk_bf16_f32 v42, v84, v85
    v_exp_f32 v88, v88
    v_exp_f32 v89, v89
    v_cvt_pk_bf16_f32 v43, v86, v87
    v_exp_f32 v90, v90
    v_exp_f32 v91, v91
    v_mfma_f32_32x32x16_bf16 v[96:111], v[32:35], v[40:43], v[96:111]
    v_exp_f32 v92, v92
    v_cvt_pk_bf16_f32 v44, v88, v89
    v_exp_f32 v93, v93
    v_cvt_pk_bf16_f32 v45, v90, v91
    v_exp_f32 v94, v94
    v_exp_f32 v95, v95
    v_cvt_pk_bf16_f32 v46, v92, v93
    v_cvt_pk_bf16_f32 v47, v94, v95
    s_waitcnt lgkmcnt(0)
    v_mfma_f32_32x32x16_bf16 v[80:95], v[16:19], v[8:11], v[48:63]
    v_exp_f32 v64, v64
    v_exp_f32 v65, v65
    v_mfma_f32_32x32x16_bf16 v[96:111], v[36:39], v[44:47], v[96:111]
    s_mov_b64 exec, s[16:17]
    ds_read_b128 v[32:35], v118 offset:17920
    ds_read_b128 v[36:39], v118 offset:18560
    s_mov_b64 exec, -1
    v_exp_f32 v66, v66
    v_exp_f32 v67, v67
    v_exp_f32 v68, v68
    v_cvt_pk_bf16_f32 v40, v64, v65
    v_mfma_f32_32x32x8_bf16 v[80:95], v[20:21], v[12:13], v[80:95]
    v_exp_f32 v69, v69
    v_cvt_pk_bf16_f32 v41, v66, v67
    ds_read_b64 v[16:17], v116 offset:20480
    ds_read_b64 v[18:19], v116 offset:20488
    ds_read_b64 v[20:21], v117 offset:20480
    v_exp_f32 v70, v70
    v_exp_f32 v71, v71
    v_cvt_pk_bf16_f32 v42, v68, v69
    v_exp_f32 v72, v72
    v_exp_f32 v73, v73
    v_cvt_pk_bf16_f32 v43, v70, v71
    v_exp_f32 v74, v74
    v_exp_f32 v75, v75
    v_mfma_f32_32x32x16_bf16 v[96:111], v[24:27], v[40:43], v[96:111]
    v_exp_f32 v76, v76
    v_cvt_pk_bf16_f32 v44, v72, v73
    v_exp_f32 v77, v77
    v_cvt_pk_bf16_f32 v45, v74, v75
    v_exp_f32 v78, v78
    v_exp_f32 v79, v79
    v_cvt_pk_bf16_f32 v46, v76, v77
    v_cvt_pk_bf16_f32 v47, v78, v79
    s_waitcnt lgkmcnt(0)
    v_mfma_f32_32x32x16_bf16 v[64:79], v[16:19], v[8:11], v[48:63]
    v_exp_f32 v80, v80
    v_exp_f32 v81, v81
    v_mfma_f32_32x32x16_bf16 v[96:111], v[28:31], v[44:47], v[96:111]
    s_mov_b64 exec, s[16:17]
    ds_read_b128 v[24:27], v118 offset:20480
    ds_read_b128 v[28:31], v118 offset:21120
    s_mov_b64 exec, -1
    v_exp_f32 v82, v82
    v_exp_f32 v83, v83
    v_exp_f32 v84, v84
    v_cvt_pk_bf16_f32 v40, v80, v81
    v_mfma_f32_32x32x8_bf16 v[64:79], v[20:21], v[12:13], v[64:79]
    v_exp_f32 v85, v85
    v_cvt_pk_bf16_f32 v41, v82, v83
    ds_read_b64 v[16:17], v116 offset:23040
    ds_read_b64 v[18:19], v116 offset:23048
    ds_read_b64 v[20:21], v117 offset:23040
    v_exp_f32 v86, v86
    v_exp_f32 v87, v87
    v_cvt_pk_bf16_f32 v42, v84, v85
    v_exp_f32 v88, v88
    v_exp_f32 v89, v89
    v_cvt_pk_bf16_f32 v43, v86, v87
    v_exp_f32 v90, v90
    v_exp_f32 v91, v91
    v_mfma_f32_32x32x16_bf16 v[96:111], v[32:35], v[40:43], v[96:111]
    v_exp_f32 v92, v92
    v_cvt_pk_bf16_f32 v44, v88, v89
    v_exp_f32 v93, v93
    v_cvt_pk_bf16_f32 v45, v90, v91
    v_exp_f32 v94, v94
    v_exp_f32 v95, v95
    v_cvt_pk_bf16_f32 v46, v92, v93
    v_cvt_pk_bf16_f32 v47, v94, v95
    v_add_u32 v116, 20480, v116
    v_add_u32 v117, 20480, v117
    v_add_u32 v118, 20480, v118
    s_add_u32 s18, s18, 1
    s_cmp_eq_u32 s18, 1
    s_cbranch_scc1 K2_BAR2
K2_BAR2_RET:
    s_cmp_lg_u32 s18, 6
    s_cbranch_scc1 K2_NOFLIP
    s_cmp_ge_u32 s14, 4
    s_cbranch_scc1 K2_NOFLIP
    s_setprio 0
K2_NOFLIP:
    s_cmp_lt_u32 s18, 8
    s_cbranch_scc1 K2_LOOP
    v_mfma_f32_32x32x16_bf16 v[96:111], v[36:39], v[44:47], v[96:111]
    s_waitcnt lgkmcnt(0)
    s_nop 15
    s_nop 3
    v_mov_b32 v112, v104
    v_mov_b32 v113, v104
    s_nop 1
    v_permlane32_swap_b32 v113, v112
    v_maximum3_f32 v114, |v96|, |v97|, |v98|
    v_maximum3_f32 v114, |v99|, |v100|, v114
    v_maximum3_f32 v114, |v101|, |v102|, v114
    v_maximum3_f32 v114, |v103|, v114, v114
    v_maximum3_f32 v115, |v104|, |v105|, |v106|
    v_maximum3_f32 v115, |v107|, v115, v114
    v_maximum3_f32 v115, v115, |v112|, |v112|
    v_mov_b32 v116, 0x7b800000
    v_mov_b32 v117, 0xd800000
    v_cmp_lt_f32 vcc, v115, v116
    v_cmp_ge_f32 s[26:27], v114, v117
    s_nop 1
    s_and_b64 s[26:27], s[26:27], vcc
    s_cmp_eq_u64 s[26:27], -1
    s_cbranch_scc1 K2_FIN
    s_cmp_lg_u32 s20, 0
    s_cbranch_scc1 K2_FIN
    s_mov_b32 s20, 1
    s_mov_b32 s21, 32
    s_mov_b32 s22, 0
    s_branch K2_SAMPLE
K2_FIN:
    s_barrier
    v_rcp_f32 v113, v112
    s_nop 0
    v_mul_f32 v96, v96, v113
    v_mul_f32 v97, v97, v113
    v_mul_f32 v98, v98, v113
    v_mul_f32 v99, v99, v113
    v_mul_f32 v100, v100, v113
    v_mul_f32 v101, v101, v113
    v_mul_f32 v102, v102, v113
    v_mul_f32 v103, v103, v113
    v_mul_f32 v104, v104, v113
    v_mul_f32 v105, v105, v113
    v_mul_f32 v106, v106, v113
    v_mul_f32 v107, v107, v113
    v_cvt_pk_bf16_f32 v40, v96, v97
    v_cvt_pk_bf16_f32 v41, v98, v99
    v_cvt_pk_bf16_f32 v42, v100, v101
    v_cvt_pk_bf16_f32 v43, v102, v103
    v_cvt_pk_bf16_f32 v44, v104, v105
    v_cvt_pk_bf16_f32 v45, v106, v107
    s_lshr_b32 s24, s24, 5
    s_mul_i32 s24, s24, 40
    s_lshr_b32 s25, s12, 2
    s_mul_i32 s25, s25, 5
    s_add_u32 s24, s24, s25
    s_and_b32 s25, s12, 3
    s_add_u32 s28, s24, s25
    s_lshl_b32 s28, s28, 10
    s_add_u32 s28, s28, 14155776
    buffer_store_dwordx4 v[40:43], v7, s[8:11], s28 offen sc0 sc1
    s_add_u32 s28, s24, 4
    s_lshl_b32 s28, s28, 10
    s_lshr_b32 s29, s25, 1
    s_lshl_b32 s29, s29, 9
    s_add_u32 s28, s28, s29
    s_and_b32 s29, s25, 1
    s_lshl_b32 s29, s29, 3
    s_add_u32 s28, s28, s29
    s_add_u32 s28, s28, 14155776
    s_mov_b32 exec_hi, 0
    buffer_store_dwordx2 v[44:45], v7, s[8:11], s28 offen sc0 sc1
    s_endpgm
K2_BAR2:
    s_cmp_lg_u32 s20, 0
    s_cbranch_scc1 K2_BAR2_RET
    s_waitcnt vmcnt(0)
    s_barrier
    s_branch K2_BAR2_RET
K2_GEMM:
    s_setprio 0
    s_load_dwordx2 s[24:25], s[0:1], 0
    s_load_dwordx2 s[28:29], s[0:1], 56
    s_sub_u32 s14, s14, 8
    v_lshlrev_b32 v3, 4, v1
    s_and_b32 s12, s2, 7
    s_lshr_b32 s13, s2, 5
    s_lshl_b32 s13, s13, 3
    s_add_u32 s12, s12, s13
    s_lshr_b32 s13, s2, 3
    s_and_b32 s13, s13, 3
    s_waitcnt lgkmcnt(0)
    s_mov_b32 s8, s4
    s_and_b32 s9, s5, 0xffff
    s_mov_b32 s10, 33554432
    s_mov_b32 s11, 0x00020000
    s_and_b32 s15, s2, 7
    s_lshl_b32 s15, s15, 2
    s_lshr_b32 s16, s2, 6
    s_add_u32 s15, s15, s16
    s_mul_i32 s15, s15, 163840
    s_lshl_b32 s16, s14, 10
    s_add_u32 s16, s16, 32768
    s_add_u32 s15, s15, s16
    s_add_u32 s15, s15, 2621440
    s_mov_b32 m0, s16
    s_barrier
    buffer_load_dwordx4 v3, s[8:11], s15 offen lds
    s_add_u32 m0, m0, 4096
    s_add_u32 s15, s15, 4096
    buffer_load_dwordx4 v3, s[8:11], s15 offen lds
    s_add_u32 m0, m0, 4096
    s_add_u32 s15, s15, 4096
    buffer_load_dwordx4 v3, s[8:11], s15 offen lds
    s_add_u32 m0, m0, 4096
    s_add_u32 s15, s15, 4096
    buffer_load_dwordx4 v3, s[8:11], s15 offen lds
    s_add_u32 m0, m0, 4096
    s_add_u32 s15, s15, 4096
    buffer_load_dwordx4 v3, s[8:11], s15 offen lds
    s_add_u32 m0, m0, 4096
    s_add_u32 s15, s15, 4096
    buffer_load_dwordx4 v3, s[8:11], s15 offen lds
    s_add_u32 m0, m0, 4096
    s_add_u32 s15, s15, 4096
    buffer_load_dwordx4 v3, s[8:11], s15 offen lds
    s_add_u32 m0, m0, 4096
    s_add_u32 s15, s15, 4096
    buffer_load_dwordx4 v3, s[8:11], s15 offen lds
    s_add_u32 m0, m0, 4096
    s_add_u32 s15, s15, 4096
    buffer_load_dwordx4 v3, s[8:11], s15 offen lds
    s_add_u32 m0, m0, 4096
    s_add_u32 s15, s15, 4096
    buffer_load_dwordx4 v3, s[8:11], s15 offen lds
    s_add_u32 m0, m0, 4096
    s_add_u32 s15, s15, 4096
    buffer_load_dwordx4 v3, s[8:11], s15 offen lds
    s_add_u32 m0, m0, 4096
    s_add_u32 s15, s15, 4096
    buffer_load_dwordx4 v3, s[8:11], s15 offen lds
    s_add_u32 m0, m0, 4096
    s_add_u32 s15, s15, 4096
    buffer_load_dwordx4 v3, s[8:11], s15 offen lds
    s_add_u32 m0, m0, 4096
    s_add_u32 s15, s15, 4096
    buffer_load_dwordx4 v3, s[8:11], s15 offen lds
    s_add_u32 m0, m0, 4096
    s_add_u32 s15, s15, 4096
    buffer_load_dwordx4 v3, s[8:11], s15 offen lds
    s_add_u32 m0, m0, 4096
    s_add_u32 s15, s15, 4096
    buffer_load_dwordx4 v3, s[8:11], s15 offen lds
    s_add_u32 m0, m0, 4096
    s_add_u32 s15, s15, 4096
    buffer_load_dwordx4 v3, s[8:11], s15 offen lds
    s_add_u32 m0, m0, 4096
    s_add_u32 s15, s15, 4096
    buffer_load_dwordx4 v3, s[8:11], s15 offen lds
    s_add_u32 m0, m0, 4096
    s_add_u32 s15, s15, 4096
    buffer_load_dwordx4 v3, s[8:11], s15 offen lds
    s_add_u32 m0, m0, 4096
    s_add_u32 s15, s15, 4096
    buffer_load_dwordx4 v3, s[8:11], s15 offen lds
    s_add_u32 m0, m0, 4096
    s_add_u32 s15, s15, 4096
    buffer_load_dwordx4 v3, s[8:11], s15 offen lds
    s_add_u32 m0, m0, 4096
    s_add_u32 s15, s15, 4096
    buffer_load_dwordx4 v3, s[8:11], s15 offen lds
    s_add_u32 m0, m0, 4096
    s_add_u32 s15, s15, 4096
    buffer_load_dwordx4 v3, s[8:11], s15 offen lds
    s_add_u32 m0, m0, 4096
    s_add_u32 s15, s15, 4096
    buffer_load_dwordx4 v3, s[8:11], s15 offen lds
    s_add_u32 m0, m0, 4096
    s_add_u32 s15, s15, 4096
    buffer_load_dwordx4 v3, s[8:11], s15 offen lds
    s_add_u32 m0, m0, 4096
    s_add_u32 s15, s15, 4096
    buffer_load_dwordx4 v3, s[8:11], s15 offen lds
    s_add_u32 m0, m0, 4096
    s_add_u32 s15, s15, 4096
    buffer_load_dwordx4 v3, s[8:11], s15 offen lds
    s_add_u32 m0, m0, 4096
    s_add_u32 s15, s15, 4096
    buffer_load_dwordx4 v3, s[8:11], s15 offen lds
    s_add_u32 m0, m0, 4096
    s_add_u32 s15, s15, 4096
    buffer_load_dwordx4 v3, s[8:11], s15 offen lds
    s_add_u32 m0, m0, 4096
    s_add_u32 s15, s15, 4096
    buffer_load_dwordx4 v3, s[8:11], s15 offen lds
    s_add_u32 m0, m0, 4096
    s_add_u32 s15, s15, 4096
    buffer_load_dwordx4 v3, s[8:11], s15 offen lds
    s_add_u32 m0, m0, 4096
    s_add_u32 s15, s15, 4096
    buffer_load_dwordx4 v3, s[8:11], s15 offen lds
    s_waitcnt vmcnt(0)
    s_barrier
    v_and_b32 v4, 31, v1
    v_lshrrev_b32 v6, 5, v1
    v_lshlrev_b32 v7, 2, v4
    s_lshl_b32 s15, s12, 7
    s_add_u32 s15, s15, 19857408
    buffer_load_dword v5, v7, s[8:11], s15 offen
    s_lshl_b32 s16, s12, 5
    v_add_u32 v7, s16, v4
    v_mul_u32_u24 v7, 1280, v7
    v_lshl_add_u32 v7, v6, 3, v7
    s_mul_i32 s17, s13, 320
    s_lshl_b32 s18, s14, 6
    s_add_u32 s18, s18, s17
    s_add_u32 s17, s17, 256
    v_add_u32 v8, s18, v7
    v_add_u32 v9, s17, v7
    v_lshlrev_b32 v10, 3, v6
    v_add_u32 v11, s17, v10
    v_add_u32 v10, s18, v10
    global_load_dwordx2 v[80:81], v8, s[24:25] offset:0
    global_load_dwordx2 v[88:89], v10, s[28:29] offset:0
    global_load_dwordx2 v[82:83], v8, s[24:25] offset:16
    global_load_dwordx2 v[90:91], v10, s[28:29] offset:16
    global_load_dwordx2 v[84:85], v8, s[24:25] offset:32
    global_load_dwordx2 v[92:93], v10, s[28:29] offset:32
    global_load_dwordx2 v[86:87], v8, s[24:25] offset:48
    global_load_dwordx2 v[94:95], v10, s[28:29] offset:48
    v_mov_b32 v16, 0
    v_mov_b32 v17, 0
    v_mov_b32 v18, 0
    v_mov_b32 v19, 0
    v_mov_b32 v20, 0
    v_mov_b32 v21, 0
    v_mov_b32 v22, 0
    v_mov_b32 v23, 0
    v_mov_b32 v24, 0
    v_mov_b32 v25, 0
    v_mov_b32 v26, 0
    v_mov_b32 v27, 0
    v_mov_b32 v28, 0
    v_mov_b32 v29, 0
    v_mov_b32 v30, 0
    v_mov_b32 v31, 0
    v_mov_b32 v32, 0
    v_mov_b32 v33, 0
    v_mov_b32 v34, 0
    v_mov_b32 v35, 0
    v_mov_b32 v36, 0
    v_mov_b32 v37, 0
    v_mov_b32 v38, 0
    v_mov_b32 v39, 0
    v_mov_b32 v40, 0
    v_mov_b32 v41, 0
    v_mov_b32 v42, 0
    v_mov_b32 v43, 0
    v_mov_b32 v44, 0
    v_mov_b32 v45, 0
    v_mov_b32 v46, 0
    v_mov_b32 v47, 0
    s_mul_i32 s22, s12, 98304
    s_add_u32 s22, s22, 7864320
    s_add_u32 s26, s22, 98304
    s_mul_i32 s23, s13, 5
    s_add_u32 s19, s23, 4
    s_add_u32 s23, s23, s14
    s_mul_i32 s23, s23, 98304
    s_add_u32 s23, s23, 16777216
    s_lshr_b32 s15, s2, 3
    s_and_b32 s15, s15, 7
    s_mul_i32 s15, s15, 12288
    s_add_u32 s20, s22, s15
    s_add_u32 s21, s23, s15
    buffer_load_dwordx4 v[48:51], v3, s[8:11], s20 offen
    buffer_load_dwordx4 v[64:67], v3, s[8:11], s21 offen
    s_add_u32 s20, s20, 1024
    s_add_u32 s21, s21, 1024
    s_cmp_eq_u32 s20, s26
    s_cselect_b32 s20, s22, s20
    s_cselect_b32 s21, s23, s21
    buffer_load_dwordx4 v[52:55], v3, s[8:11], s20 offen
    buffer_load_dwordx4 v[68:71], v3, s[8:11], s21 offen
    s_add_u32 s20, s20, 1024
    s_add_u32 s21, s21, 1024
    s_cmp_eq_u32 s20, s26
    s_cselect_b32 s20, s22, s20
    s_cselect_b32 s21, s23, s21
    buffer_load_dwordx4 v[56:59], v3, s[8:11], s20 offen
    buffer_load_dwordx4 v[72:75], v3, s[8:11], s21 offen
    s_add_u32 s20, s20, 1024
    s_add_u32 s21, s21, 1024
    s_cmp_eq_u32 s20, s26
    s_cselect_b32 s20, s22, s20
    s_cselect_b32 s21, s23, s21
    s_mov_b32 s27, 24
K2G_LA:
    buffer_load_dwordx4 v[60:63], v3, s[8:11], s20 offen
    buffer_load_dwordx4 v[76:79], v3, s[8:11], s21 offen
    s_add_u32 s20, s20, 1024
    s_add_u32 s21, s21, 1024
    s_cmp_eq_u32 s20, s26
    s_cselect_b32 s20, s22, s20
    s_cselect_b32 s21, s23, s21
    s_waitcnt vmcnt(6)
    v_mfma_f32_32x32x16_bf16 v[16:31], v[64:67], v[48:51], v[16:31]
    buffer_load_dwordx4 v[48:51], v3, s[8:11], s20 offen
    buffer_load_dwordx4 v[64:67], v3, s[8:11], s21 offen
    s_add_u32 s20, s20, 1024
    s_add_u32 s21, s21, 1024
    s_cmp_eq_u32 s20, s26
    s_cselect_b32 s20, s22, s20
    s_cselect_b32 s21, s23, s21
    s_waitcnt vmcnt(6)
    v_mfma_f32_32x32x16_bf16 v[16:31], v[68:71], v[52:55], v[16:31]
    buffer_load_dwordx4 v[52:55], v3, s[8:11], s20 offen
    buffer_load_dwordx4 v[68:71], v3, s[8:11], s21 offen
    s_add_u32 s20, s20, 1024
    s_add_u32 s21, s21, 1024
    s_cmp_eq_u32 s20, s26
    s_cselect_b32 s20, s22, s20
    s_cselect_b32 s21, s23, s21
    s_waitcnt vmcnt(6)
    v_mfma_f32_32x32x16_bf16 v[16:31], v[72:75], v[56:59], v[16:31]
    buffer_load_dwordx4 v[56:59], v3, s[8:11], s20 offen
    buffer_load_dwordx4 v[72:75], v3, s[8:11], s21 offen
    s_add_u32 s20, s20, 1024
    s_add_u32 s21, s21, 1024
    s_cmp_eq_u32 s20, s26
    s_cselect_b32 s20, s22, s20
    s_cselect_b32 s21, s23, s21
    s_waitcnt vmcnt(6)
    v_mfma_f32_32x32x16_bf16 v[16:31], v[76:79], v[60:63], v[16:31]
    s_sub_u32 s27, s27, 1
    s_cmp_lg_u32 s27, 0
    s_cbranch_scc1 K2G_LA
    s_lshr_b32 s15, s2, 3
    s_lshl_b32 s15, s15, 2
    s_add_u32 s15, s15, s14
    s_lshl_b32 s15, s15, 13
    s_add_u32 s15, s15, 18743296
    v_lshlrev_b32 v13, 7, v1
    buffer_load_dword v14, v13, s[8:11], s15 offen
    s_mul_i32 s15, s14, 24576
    s_add_u32 s22, s22, s15
    s_add_u32 s26, s22, 24576
    s_mul_i32 s23, s19, 98304
    s_add_u32 s23, s23, 16777216
    s_add_u32 s23, s23, s15
    s_mov_b32 s20, s22
    s_mov_b32 s21, s23
    buffer_load_dwordx4 v[48:51], v3, s[8:11], s20 offen
    buffer_load_dwordx4 v[64:67], v3, s[8:11], s21 offen
    s_add_u32 s20, s20, 1024
    s_add_u32 s21, s21, 1024
    s_cmp_eq_u32 s20, s26
    s_cselect_b32 s20, s22, s20
    s_cselect_b32 s21, s23, s21
    buffer_load_dwordx4 v[52:55], v3, s[8:11], s20 offen
    buffer_load_dwordx4 v[68:71], v3, s[8:11], s21 offen
    s_add_u32 s20, s20, 1024
    s_add_u32 s21, s21, 1024
    s_cmp_eq_u32 s20, s26
    s_cselect_b32 s20, s22, s20
    s_cselect_b32 s21, s23, s21
    buffer_load_dwordx4 v[56:59], v3, s[8:11], s20 offen
    buffer_load_dwordx4 v[72:75], v3, s[8:11], s21 offen
    s_add_u32 s20, s20, 1024
    s_add_u32 s21, s21, 1024
    s_cmp_eq_u32 s20, s26
    s_cselect_b32 s20, s22, s20
    s_cselect_b32 s21, s23, s21
    s_mov_b32 s27, 6
K2G_LB:
    buffer_load_dwordx4 v[60:63], v3, s[8:11], s20 offen
    buffer_load_dwordx4 v[76:79], v3, s[8:11], s21 offen
    s_add_u32 s20, s20, 1024
    s_add_u32 s21, s21, 1024
    s_cmp_eq_u32 s20, s26
    s_cselect_b32 s20, s22, s20
    s_cselect_b32 s21, s23, s21
    s_waitcnt vmcnt(6)
    v_mfma_f32_32x32x16_bf16 v[32:47], v[64:67], v[48:51], v[32:47]
    buffer_load_dwordx4 v[48:51], v3, s[8:11], s20 offen
    buffer_load_dwordx4 v[64:67], v3, s[8:11], s21 offen
    s_add_u32 s20, s20, 1024
    s_add_u32 s21, s21, 1024
    s_cmp_eq_u32 s20, s26
    s_cselect_b32 s20, s22, s20
    s_cselect_b32 s21, s23, s21
    s_waitcnt vmcnt(6)
    v_mfma_f32_32x32x16_bf16 v[32:47], v[68:71], v[52:55], v[32:47]
    buffer_load_dwordx4 v[52:55], v3, s[8:11], s20 offen
    buffer_load_dwordx4 v[68:71], v3, s[8:11], s21 offen
    s_add_u32 s20, s20, 1024
    s_add_u32 s21, s21, 1024
    s_cmp_eq_u32 s20, s26
    s_cselect_b32 s20, s22, s20
    s_cselect_b32 s21, s23, s21
    s_waitcnt vmcnt(6)
    v_mfma_f32_32x32x16_bf16 v[32:47], v[72:75], v[56:59], v[32:47]
    buffer_load_dwordx4 v[56:59], v3, s[8:11], s20 offen
    buffer_load_dwordx4 v[72:75], v3, s[8:11], s21 offen
    s_add_u32 s20, s20, 1024
    s_add_u32 s21, s21, 1024
    s_cmp_eq_u32 s20, s26
    s_cselect_b32 s20, s22, s20
    s_cselect_b32 s21, s23, s21
    s_waitcnt vmcnt(6)
    v_mfma_f32_32x32x16_bf16 v[32:47], v[76:79], v[60:63], v[32:47]
    s_sub_u32 s27, s27, 1
    s_cmp_lg_u32 s27, 0
    s_cbranch_scc1 K2G_LB
    s_setprio 3
    s_waitcnt vmcnt(0)
    s_nop 15
    v_mul_f32 v32, v32, v5
    v_mul_f32 v33, v33, v5
    v_mul_f32 v34, v34, v5
    v_mul_f32 v35, v35, v5
    v_mul_f32 v36, v36, v5
    v_mul_f32 v37, v37, v5
    v_mul_f32 v38, v38, v5
    v_mul_f32 v39, v39, v5
    v_mul_f32 v40, v40, v5
    v_mul_f32 v41, v41, v5
    v_mul_f32 v42, v42, v5
    v_mul_f32 v43, v43, v5
    v_mul_f32 v44, v44, v5
    v_mul_f32 v45, v45, v5
    v_mul_f32 v46, v46, v5
    v_mul_f32 v47, v47, v5
    v_mul_f32 v16, v16, v5
    v_mul_f32 v17, v17, v5
    v_mul_f32 v18, v18, v5
    v_mul_f32 v19, v19, v5
    v_mul_f32 v20, v20, v5
    v_mul_f32 v21, v21, v5
    v_mul_f32 v22, v22, v5
    v_mul_f32 v23, v23, v5
    v_mul_f32 v24, v24, v5
    v_mul_f32 v25, v25, v5
    v_mul_f32 v26, v26, v5
    v_mul_f32 v27, v27, v5
    v_mul_f32 v28, v28, v5
    v_mul_f32 v29, v29, v5
    v_mul_f32 v30, v30, v5
    v_mul_f32 v31, v31, v5
    v_lshlrev_b32 v12, 16, v80
    v_add_f32 v16, v16, v12
    v_lshlrev_b32 v12, 16, v88
    v_add_f32 v16, v16, v12
    v_and_b32 v12, 0xffff0000, v80
    v_add_f32 v17, v17, v12
    v_and_b32 v12, 0xffff0000, v88
    v_add_f32 v17, v17, v12
    v_lshlrev_b32 v12, 16, v81
    v_add_f32 v18, v18, v12
    v_lshlrev_b32 v12, 16, v89
    v_add_f32 v18, v18, v12
    v_and_b32 v12, 0xffff0000, v81
    v_add_f32 v19, v19, v12
    v_and_b32 v12, 0xffff0000, v89
    v_add_f32 v19, v19, v12
    v_lshlrev_b32 v12, 16, v82
    v_add_f32 v20, v20, v12
    v_lshlrev_b32 v12, 16, v90
    v_add_f32 v20, v20, v12
    v_and_b32 v12, 0xffff0000, v82
    v_add_f32 v21, v21, v12
    v_and_b32 v12, 0xffff0000, v90
    v_add_f32 v21, v21, v12
    v_lshlrev_b32 v12, 16, v83
    v_add_f32 v22, v22, v12
    v_lshlrev_b32 v12, 16, v91
    v_add_f32 v22, v22, v12
    v_and_b32 v12, 0xffff0000, v83
    v_add_f32 v23, v23, v12
    v_and_b32 v12, 0xffff0000, v91
    v_add_f32 v23, v23, v12
    v_lshlrev_b32 v12, 16, v84
    v_add_f32 v24, v24, v12
    v_lshlrev_b32 v12, 16, v92
    v_add_f32 v24, v24, v12
    v_and_b32 v12, 0xffff0000, v84
    v_add_f32 v25, v25, v12
    v_and_b32 v12, 0xffff0000, v92
    v_add_f32 v25, v25, v12
    v_lshlrev_b32 v12, 16, v85
    v_add_f32 v26, v26, v12
    v_lshlrev_b32 v12, 16, v93
    v_add_f32 v26, v26, v12
    v_and_b32 v12, 0xffff0000, v85
    v_add_f32 v27, v27, v12
    v_and_b32 v12, 0xffff0000, v93
    v_add_f32 v27, v27, v12
    v_lshlrev_b32 v12, 16, v86
    v_add_f32 v28, v28, v12
    v_lshlrev_b32 v12, 16, v94
    v_add_f32 v28, v28, v12
    v_and_b32 v12, 0xffff0000, v86
    v_add_f32 v29, v29, v12
    v_and_b32 v12, 0xffff0000, v94
    v_add_f32 v29, v29, v12
    v_lshlrev_b32 v12, 16, v87
    v_add_f32 v30, v30, v12
    v_lshlrev_b32 v12, 16, v95
    v_add_f32 v30, v30, v12
    v_and_b32 v12, 0xffff0000, v87
    v_add_f32 v31, v31, v12
    v_and_b32 v12, 0xffff0000, v95
    v_add_f32 v31, v31, v12
    s_load_dwordx2 s[30:31], s[0:1], 72
    s_load_dwordx2 s[34:35], s[0:1], 64
    s_mul_i32 s36, s13, 5
    s_add_u32 s37, s36, 4
    s_add_u32 s36, s36, s14
    s_mul_i32 s36, s36, 40960
    s_add_u32 s36, s36, 18743296
    s_mov_b32 s63, s36
    s_mul_i32 s37, s37, 40960
    s_add_u32 s37, s37, 18743296
    s_mul_i32 s38, s14, 10240
    s_add_u32 s37, s37, s38
    buffer_load_dwordx4 v[48:51], v3, s[8:11], s37 offen offset:0
    buffer_load_dwordx4 v[52:55], v3, s[8:11], s37 offen offset:1024
    buffer_load_dwordx4 v[56:59], v3, s[8:11], s37 offen offset:2048
    buffer_load_dwordx4 v[60:63], v3, s[8:11], s37 offen offset:3072
    s_add_u32 s37, s37, 4096
    buffer_load_dwordx4 v[64:67], v3, s[8:11], s37 offen offset:0
    buffer_load_dwordx4 v[68:71], v3, s[8:11], s37 offen offset:1024
    buffer_load_dwordx4 v[72:75], v3, s[8:11], s37 offen offset:2048
    buffer_load_dwordx4 v[76:79], v3, s[8:11], s37 offen offset:3072
    s_add_u32 s37, s37, 4096
    buffer_load_dwordx4 v[80:83], v3, s[8:11], s37 offen offset:0
    buffer_load_dwordx4 v[84:87], v3, s[8:11], s37 offen offset:1024
    s_add_u32 s62, s63, 0
    buffer_load_dwordx4 v[88:91], v3, s[8:11], s62 offen offset:0
    s_add_u32 s62, s63, 0
    buffer_load_dwordx4 v[92:95], v3, s[8:11], s62 offen offset:1024
    s_add_u32 s62, s63, 0
    buffer_load_dwordx4 v[96:99], v3, s[8:11], s62 offen offset:2048
    s_add_u32 s62, s63, 0
    buffer_load_dwordx4 v[100:103], v3, s[8:11], s62 offen offset:3072
    s_add_u32 s62, s63, 4096
    buffer_load_dwordx4 v[104:107], v3, s[8:11], s62 offen offset:0
    s_add_u32 s62, s63, 4096
    buffer_load_dwordx4 v[108:111], v3, s[8:11], s62 offen offset:1024
    s_add_u32 s62, s63, 4096
    buffer_load_dwordx4 v[112:115], v3, s[8:11], s62 offen offset:2048
    s_add_u32 s62, s63, 4096
    buffer_load_dwordx4 v[116:119], v3, s[8:11], s62 offen offset:3072
    s_add_u32 s62, s63, 8192
    buffer_load_dwordx4 v[120:123], v3, s[8:11], s62 offen offset:0
    s_add_u32 s62, s63, 8192
    buffer_load_dwordx4 v[124:127], v3, s[8:11], s62 offen offset:1024
    s_waitcnt lgkmcnt(0)
    s_barrier
    s_mul_i32 s39, s12, 40960
    s_add_u32 s39, s39, s38
    s_add_u32 s39, s39, 14155776
    s_mov_b32 s15, 0
    v_lshrrev_b32 v1, 4, v3
    v_min_u32 v1, 39, v1
    v_lshrrev_b32 v0, 2, v1
    v_lshlrev_b32 v0, 10, v0
    v_and_b32 v12, 1, v1
    v_lshl_add_u32 v0, v12, 3, v0
    v_bfe_u32 v12, v1, 1, 1
    v_lshl_add_u32 v0, v12, 9, v0
K2F_LP:
    buffer_load_dword v13, v0, s[8:11], s39 offen sc1
    s_add_u32 s15, s15, 1
    s_waitcnt vmcnt(0)
    v_cmp_eq_u32 vcc, -1, v13
    s_cmp_lt_u32 s15, 0x8000
    s_cbranch_scc0 K2F_POLL
    s_cbranch_vccz K2F_POLL
    s_sleep 1
    s_branch K2F_LP
K2F_POLL:
    s_mov_b32 s16, s39
    buffer_load_dwordx4 v[128:131], v3, s[8:11], s16 offen offset:0 sc1
    buffer_load_dwordx4 v[132:135], v3, s[8:11], s16 offen offset:1024 sc1
    buffer_load_dwordx4 v[136:139], v3, s[8:11], s16 offen offset:2048 sc1
    buffer_load_dwordx4 v[140:143], v3, s[8:11], s16 offen offset:3072 sc1
    s_add_u32 s16, s16, 4096
    buffer_load_dwordx4 v[144:147], v3, s[8:11], s16 offen offset:0 sc1
    buffer_load_dwordx4 v[148:151], v3, s[8:11], s16 offen offset:1024 sc1
    buffer_load_dwordx4 v[152:155], v3, s[8:11], s16 offen offset:2048 sc1
    buffer_load_dwordx4 v[156:159], v3, s[8:11], s16 offen offset:3072 sc1
    s_add_u32 s16, s16, 4096
    buffer_load_dwordx4 v[160:163], v3, s[8:11], s16 offen offset:0 sc1
    buffer_load_dwordx4 v[164:167], v3, s[8:11], s16 offen offset:1024 sc1
    s_waitcnt vmcnt(9)
    v_max3_u32 v12, v128, v129, v130
    v_max_u32 v12, v12, v131
    s_waitcnt vmcnt(8)
    v_max3_u32 v12, v132, v133, v12
    v_max3_u32 v12, v134, v135, v12
    s_waitcnt vmcnt(7)
    v_max3_u32 v12, v136, v137, v12
    v_max3_u32 v12, v138, v139, v12
    s_waitcnt vmcnt(6)
    v_max3_u32 v12, v140, v141, v12
    v_max3_u32 v12, v142, v143, v12
    s_waitcnt vmcnt(5)
    v_max3_u32 v12, v144, v145, v12
    v_max3_u32 v12, v146, v147, v12
    s_waitcnt vmcnt(4)
    v_max3_u32 v12, v148, v149, v12
    v_max3_u32 v12, v150, v151, v12
    s_waitcnt vmcnt(3)
    v_max3_u32 v12, v152, v153, v12
    v_max3_u32 v12, v154, v155, v12
    s_waitcnt vmcnt(2)
    v_max3_u32 v12, v156, v157, v12
    v_max3_u32 v12, v158, v159, v12
    s_waitcnt vmcnt(1)
    v_max3_u32 v12, v160, v161, v12
    v_max3_u32 v12, v162, v163, v12
    s_waitcnt vmcnt(0)
    v_max3_u32 v12, v164, v165, v12
    v_max3_u32 v12, v166, v167, v12
    v_cmp_eq_u32 vcc, -1, v12
    s_add_u32 s15, s15, 1
    s_cbranch_vccz K2F_GO
    s_sleep 2
    s_cmp_lt_u32 s15, 0x9000
    s_cbranch_scc1 K2F_POLL
K2F_GO:
    v_add_u32 v2, s38, v3
    ds_write_b128 v2, v[128:131] offset:0
    ds_write_b128 v2, v[132:135] offset:1024
    ds_write_b128 v2, v[136:139] offset:2048
    ds_write_b128 v2, v[140:143] offset:3072
    ds_write_b128 v2, v[144:147] offset:4096
    ds_write_b128 v2, v[148:151] offset:5120
    ds_write_b128 v2, v[152:155] offset:6144
    ds_write_b128 v2, v[156:159] offset:7168
    ds_write_b128 v2, v[160:163] offset:8192
    ds_write_b128 v2, v[164:167] offset:9216
    v_mfma_f32_32x32x16_bf16 v[32:47], v[48:51], v[128:131], v[32:47]
    s_add_u32 s62, s63, 20480
    buffer_load_dwordx4 v[48:51], v3, s[8:11], s62 offen offset:0
    v_mfma_f32_32x32x16_bf16 v[32:47], v[52:55], v[132:135], v[32:47]
    s_add_u32 s62, s63, 20480
    buffer_load_dwordx4 v[52:55], v3, s[8:11], s62 offen offset:1024
    v_mfma_f32_32x32x16_bf16 v[32:47], v[56:59], v[136:139], v[32:47]
    s_add_u32 s62, s63, 20480
    buffer_load_dwordx4 v[56:59], v3, s[8:11], s62 offen offset:2048
    v_mfma_f32_32x32x16_bf16 v[32:47], v[60:63], v[140:143], v[32:47]
    s_add_u32 s62, s63, 20480
    buffer_load_dwordx4 v[60:63], v3, s[8:11], s62 offen offset:3072
    v_mfma_f32_32x32x16_bf16 v[32:47], v[64:67], v[144:147], v[32:47]
    s_add_u32 s62, s63, 24576
    buffer_load_dwordx4 v[64:67], v3, s[8:11], s62 offen offset:0
    v_mfma_f32_32x32x16_bf16 v[32:47], v[68:71], v[148:151], v[32:47]
    s_add_u32 s62, s63, 24576
    buffer_load_dwordx4 v[68:71], v3, s[8:11], s62 offen offset:1024
    v_mfma_f32_32x32x16_bf16 v[32:47], v[72:75], v[152:155], v[32:47]
    s_add_u32 s62, s63, 24576
    buffer_load_dwordx4 v[72:75], v3, s[8:11], s62 offen offset:2048
    v_mfma_f32_32x32x16_bf16 v[32:47], v[76:79], v[156:159], v[32:47]
    s_add_u32 s62, s63, 24576
    buffer_load_dwordx4 v[76:79], v3, s[8:11], s62 offen offset:3072
    v_mfma_f32_32x32x16_bf16 v[32:47], v[80:83], v[160:163], v[32:47]
    s_add_u32 s62, s63, 28672
    buffer_load_dwordx4 v[80:83], v3, s[8:11], s62 offen offset:0
    v_mfma_f32_32x32x16_bf16 v[32:47], v[84:87], v[164:167], v[32:47]
    s_add_u32 s62, s63, 28672
    buffer_load_dwordx4 v[84:87], v3, s[8:11], s62 offen offset:1024
    s_waitcnt lgkmcnt(0)
    s_barrier
    s_add_u32 s62, s63, 8192
    buffer_load_dwordx4 v[128:131], v3, s[8:11], s62 offen offset:2048
    s_add_u32 s62, s63, 8192
    buffer_load_dwordx4 v[132:135], v3, s[8:11], s62 offen offset:3072
    s_add_u32 s62, s63, 12288
    buffer_load_dwordx4 v[136:139], v3, s[8:11], s62 offen offset:0
    s_add_u32 s62, s63, 12288
    buffer_load_dwordx4 v[140:143], v3, s[8:11], s62 offen offset:1024
    s_add_u32 s62, s63, 12288
    buffer_load_dwordx4 v[144:147], v3, s[8:11], s62 offen offset:2048
    s_add_u32 s62, s63, 12288
    buffer_load_dwordx4 v[148:151], v3, s[8:11], s62 offen offset:3072
    s_add_u32 s62, s63, 16384
    buffer_load_dwordx4 v[152:155], v3, s[8:11], s62 offen offset:0
    s_add_u32 s62, s63, 16384
    buffer_load_dwordx4 v[156:159], v3, s[8:11], s62 offen offset:1024
    s_add_u32 s62, s63, 16384
    buffer_load_dwordx4 v[160:163], v3, s[8:11], s62 offen offset:2048
    s_add_u32 s62, s63, 16384
    buffer_load_dwordx4 v[164:167], v3, s[8:11], s62 offen offset:3072
    ds_read_b128 v[4:7], v3 offset:0
    ds_read_b128 v[8:11], v3 offset:1024
    ds_read_b128 v[12:15], v3 offset:2048
    s_waitcnt lgkmcnt(2)
    v_mfma_f32_32x32x16_bf16 v[16:31], v[88:91], v[4:7], v[16:31]
    s_add_u32 s62, s63, 28672
    buffer_load_dwordx4 v[88:91], v3, s[8:11], s62 offen offset:2048
    ds_read_b128 v[4:7], v3 offset:3072
    s_waitcnt lgkmcnt(2)
    v_mfma_f32_32x32x16_bf16 v[16:31], v[92:95], v[8:11], v[16:31]
    s_add_u32 s62, s63, 28672
    buffer_load_dwordx4 v[92:95], v3, s[8:11], s62 offen offset:3072
    ds_read_b128 v[8:11], v3 offset:4096
    s_waitcnt lgkmcnt(2)
    v_mfma_f32_32x32x16_bf16 v[16:31], v[96:99], v[12:15], v[16:31]
    s_add_u32 s62, s63, 32768
    buffer_load_dwordx4 v[96:99], v3, s[8:11], s62 offen offset:0
    s_lshl_b32 s19, s14, 12
    s_add_u32 s19, s19, 40960
    v_add_u32 v1, s19, v3
    s_nop 4
    ds_write_b128 v1, v[32:35] offset:0
    ds_write_b128 v1, v[36:39] offset:1024
    ds_write_b128 v1, v[40:43] offset:2048
    ds_write_b128 v1, v[44:47] offset:3072
    s_waitcnt lgkmcnt(0)
    ds_read_b128 v[12:15], v3 offset:5120
    s_waitcnt lgkmcnt(2)
    v_mfma_f32_32x32x16_bf16 v[16:31], v[100:103], v[4:7], v[16:31]
    s_add_u32 s62, s63, 32768
    buffer_load_dwordx4 v[100:103], v3, s[8:11], s62 offen offset:1024
    ds_read_b128 v[4:7], v3 offset:6144
    s_waitcnt lgkmcnt(2)
    v_mfma_f32_32x32x16_bf16 v[16:31], v[104:107], v[8:11], v[16:31]
    s_add_u32 s62, s63, 32768
    buffer_load_dwordx4 v[104:107], v3, s[8:11], s62 offen offset:2048
    ds_read_b128 v[8:11], v3 offset:7168
    s_waitcnt lgkmcnt(2)
    v_mfma_f32_32x32x16_bf16 v[16:31], v[108:111], v[12:15], v[16:31]
    s_add_u32 s62, s63, 32768
    buffer_load_dwordx4 v[108:111], v3, s[8:11], s62 offen offset:3072
    ds_read_b128 v[12:15], v3 offset:8192
    s_waitcnt lgkmcnt(2)
    v_mfma_f32_32x32x16_bf16 v[16:31], v[112:115], v[4:7], v[16:31]
    s_add_u32 s62, s63, 36864
    buffer_load_dwordx4 v[112:115], v3, s[8:11], s62 offen offset:0
    ds_read_b128 v[4:7], v3 offset:9216
    s_waitcnt lgkmcnt(2)
    v_mfma_f32_32x32x16_bf16 v[16:31], v[116:119], v[8:11], v[16:31]
    s_add_u32 s62, s63, 36864
    buffer_load_dwordx4 v[116:119], v3, s[8:11], s62 offen offset:1024
    ds_read_b128 v[8:11], v3 offset:10240
    s_waitcnt lgkmcnt(2)
    v_mfma_f32_32x32x16_bf16 v[16:31], v[120:123], v[12:15], v[16:31]
    s_add_u32 s62, s63, 36864
    buffer_load_dwordx4 v[120:123], v3, s[8:11], s62 offen offset:2048
    ds_read_b128 v[12:15], v3 offset:11264
    s_waitcnt lgkmcnt(2)
    v_mfma_f32_32x32x16_bf16 v[16:31], v[124:127], v[4:7], v[16:31]
    s_add_u32 s62, s63, 36864
    buffer_load_dwordx4 v[124:127], v3, s[8:11], s62 offen offset:3072
    ds_read_b128 v[4:7], v3 offset:12288
    s_waitcnt vmcnt(19)
    s_waitcnt lgkmcnt(2)
    v_mfma_f32_32x32x16_bf16 v[16:31], v[128:131], v[8:11], v[16:31]
    ds_read_b128 v[8:11], v3 offset:13312
    s_waitcnt vmcnt(18)
    s_waitcnt lgkmcnt(2)
    v_mfma_f32_32x32x16_bf16 v[16:31], v[132:135], v[12:15], v[16:31]
    v_lshrrev_b32 v1, 4, v3
    v_and_b32 v0, 31, v1
    s_lshl_b32 s16, s12, 5
    v_add_u32 v0, s16, v0
    v_mul_u32_u24 v0, 1280, v0
    v_lshrrev_b32 v1, 5, v1
    v_lshlrev_b32 v1, 3, v1
    s_mul_i32 s16, s13, 320
    s_add_u32 s16, s16, 256
    s_lshl_b32 s19, s14, 4
    s_add_u32 s16, s16, s19
    v_add_u32 v1, s16, v1
    v_add_u32 v0, v0, v1
    global_load_dwordx2 v[128:129], v0, s[24:25]
    global_load_dwordx2 v[130:131], v1, s[28:29]
    ds_read_b128 v[12:15], v3 offset:14336
    s_waitcnt vmcnt(19)
    s_waitcnt lgkmcnt(2)
    v_mfma_f32_32x32x16_bf16 v[16:31], v[136:139], v[4:7], v[16:31]
    ds_read_b128 v[4:7], v3 offset:15360
    s_waitcnt vmcnt(18)
    s_waitcnt lgkmcnt(2)
    v_mfma_f32_32x32x16_bf16 v[16:31], v[140:143], v[8:11], v[16:31]
    ds_read_b128 v[8:11], v3 offset:16384
    s_waitcnt vmcnt(17)
    s_waitcnt lgkmcnt(2)
    v_mfma_f32_32x32x16_bf16 v[16:31], v[144:147], v[12:15], v[16:31]
    ds_read_b128 v[12:15], v3 offset:17408
    s_waitcnt vmcnt(16)
    s_waitcnt lgkmcnt(2)
    v_mfma_f32_32x32x16_bf16 v[16:31], v[148:151], v[4:7], v[16:31]
    ds_read_b128 v[4:7], v3 offset:18432
    s_waitcnt vmcnt(15)
    s_waitcnt lgkmcnt(2)
    v_mfma_f32_32x32x16_bf16 v[16:31], v[152:155], v[8:11], v[16:31]
    ds_read_b128 v[8:11], v3 offset:19456
    s_waitcnt vmcnt(14)
    s_waitcnt lgkmcnt(2)
    v_mfma_f32_32x32x16_bf16 v[16:31], v[156:159], v[12:15], v[16:31]
    ds_read_b128 v[12:15], v3 offset:20480
    s_waitcnt vmcnt(13)
    s_waitcnt lgkmcnt(2)
    v_mfma_f32_32x32x16_bf16 v[16:31], v[160:163], v[4:7], v[16:31]
    ds_read_b128 v[4:7], v3 offset:21504
    s_waitcnt vmcnt(12)
    s_waitcnt lgkmcnt(2)
    v_mfma_f32_32x32x16_bf16 v[16:31], v[164:167], v[8:11], v[16:31]
    ds_read_b128 v[8:11], v3 offset:22528
    s_waitcnt lgkmcnt(2)
    v_mfma_f32_32x32x16_bf16 v[16:31], v[48:51], v[12:15], v[16:31]
    ds_read_b128 v[12:15], v3 offset:23552
    s_waitcnt lgkmcnt(2)
    v_mfma_f32_32x32x16_bf16 v[16:31], v[52:55], v[4:7], v[16:31]
    ds_read_b128 v[4:7], v3 offset:24576
    s_waitcnt lgkmcnt(2)
    v_mfma_f32_32x32x16_bf16 v[16:31], v[56:59], v[8:11], v[16:31]
    ds_read_b128 v[8:11], v3 offset:25600
    s_waitcnt lgkmcnt(2)
    v_mfma_f32_32x32x16_bf16 v[16:31], v[60:63], v[12:15], v[16:31]
    ds_read_b128 v[12:15], v3 offset:26624
    s_waitcnt lgkmcnt(2)
    v_mfma_f32_32x32x16_bf16 v[16:31], v[64:67], v[4:7], v[16:31]
    ds_read_b128 v[4:7], v3 offset:27648
    s_waitcnt lgkmcnt(2)
    v_mfma_f32_32x32x16_bf16 v[16:31], v[68:71], v[8:11], v[16:31]
    ds_read_b128 v[8:11], v3 offset:28672
    s_waitcnt lgkmcnt(2)
    v_mfma_f32_32x32x16_bf16 v[16:31], v[72:75], v[12:15], v[16:31]
    ds_read_b128 v[12:15], v3 offset:29696
    s_waitcnt lgkmcnt(2)
    v_mfma_f32_32x32x16_bf16 v[16:31], v[76:79], v[4:7], v[16:31]
    ds_read_b128 v[4:7], v3 offset:30720
    s_waitcnt lgkmcnt(2)
    v_mfma_f32_32x32x16_bf16 v[16:31], v[80:83], v[8:11], v[16:31]
    ds_read_b128 v[8:11], v3 offset:31744
    s_waitcnt lgkmcnt(2)
    v_mfma_f32_32x32x16_bf16 v[16:31], v[84:87], v[12:15], v[16:31]
    ds_read_b128 v[12:15], v3 offset:32768
    s_waitcnt vmcnt(11)
    s_waitcnt lgkmcnt(2)
    v_mfma_f32_32x32x16_bf16 v[16:31], v[88:91], v[4:7], v[16:31]
    ds_read_b128 v[4:7], v3 offset:33792
    s_waitcnt vmcnt(10)
    s_waitcnt lgkmcnt(2)
    v_mfma_f32_32x32x16_bf16 v[16:31], v[92:95], v[8:11], v[16:31]
    ds_read_b128 v[8:11], v3 offset:34816
    s_waitcnt vmcnt(9)
    s_waitcnt lgkmcnt(2)
    v_mfma_f32_32x32x16_bf16 v[16:31], v[96:99], v[12:15], v[16:31]
    ds_read_b128 v[12:15], v3 offset:35840
    s_waitcnt vmcnt(8)
    s_waitcnt lgkmcnt(2)
    v_mfma_f32_32x32x16_bf16 v[16:31], v[100:103], v[4:7], v[16:31]
    ds_read_b128 v[4:7], v3 offset:36864
    s_waitcnt vmcnt(7)
    s_waitcnt lgkmcnt(2)
    v_mfma_f32_32x32x16_bf16 v[16:31], v[104:107], v[8:11], v[16:31]
    ds_read_b128 v[8:11], v3 offset:37888
    s_waitcnt vmcnt(6)
    s_waitcnt lgkmcnt(2)
    v_mfma_f32_32x32x16_bf16 v[16:31], v[108:111], v[12:15], v[16:31]
    ds_read_b128 v[12:15], v3 offset:38912
    s_waitcnt vmcnt(5)
    s_waitcnt lgkmcnt(2)
    v_mfma_f32_32x32x16_bf16 v[16:31], v[112:115], v[4:7], v[16:31]
    ds_read_b128 v[4:7], v3 offset:39936
    s_waitcnt vmcnt(4)
    s_waitcnt lgkmcnt(2)
    v_mfma_f32_32x32x16_bf16 v[16:31], v[116:119], v[8:11], v[16:31]
    s_waitcnt vmcnt(3)
    s_waitcnt lgkmcnt(1)
    v_mfma_f32_32x32x16_bf16 v[16:31], v[120:123], v[12:15], v[16:31]
    s_waitcnt vmcnt(2)
    s_waitcnt lgkmcnt(0)
    v_mfma_f32_32x32x16_bf16 v[16:31], v[124:127], v[4:7], v[16:31]
    s_barrier
    s_lshl_b32 s19, s14, 10
    s_add_u32 s19, s19, 40960
    v_add_u32 v1, s19, v3
    ds_read_b128 v[48:51], v1 offset:0
    ds_read_b128 v[52:55], v1 offset:4096
    ds_read_b128 v[56:59], v1 offset:8192
    ds_read_b128 v[60:63], v1 offset:12288
    v_lshrrev_b32 v1, 4, v3
    v_and_b32 v5, 31, v1
    v_lshrrev_b32 v6, 5, v1
    v_mul_u32_u24 v7, 336, v5
    v_lshl_add_u32 v7, v6, 3, v7
    v_add_u32 v7, 57344, v7
    s_lshl_b32 s19, s14, 6
    v_add_u32 v8, s19, v7
    s_lshl_b32 s19, s14, 4
    v_add_u32 v9, s19, v7
    s_nop 4
    v_cvt_pk_bf16_f32 v64, v16, v17
    v_cvt_pk_bf16_f32 v65, v18, v19
    v_cvt_pk_bf16_f32 v66, v20, v21
    v_cvt_pk_bf16_f32 v67, v22, v23
    v_cvt_pk_bf16_f32 v68, v24, v25
    v_cvt_pk_bf16_f32 v69, v26, v27
    v_cvt_pk_bf16_f32 v70, v28, v29
    v_cvt_pk_bf16_f32 v71, v30, v31
    ds_write_b64 v8, v[64:65] offset:0
    ds_write_b64 v8, v[66:67] offset:16
    ds_write_b64 v8, v[68:69] offset:32
    ds_write_b64 v8, v[70:71] offset:48
    s_waitcnt lgkmcnt(4)
    v_add_f32 v48, v48, v52
    v_add_f32 v56, v56, v60
    v_add_f32 v48, v48, v56
    v_add_f32 v49, v49, v53
    v_add_f32 v57, v57, v61
    v_add_f32 v49, v49, v57
    v_add_f32 v50, v50, v54
    v_add_f32 v58, v58, v62
    v_add_f32 v50, v50, v58
    v_add_f32 v51, v51, v55
    v_add_f32 v59, v59, v63
    v_add_f32 v51, v51, v59
    s_waitcnt vmcnt(0)
    v_lshlrev_b32 v132, 16, v128
    v_and_b32 v133, 0xffff0000, v128
    v_add_f32 v48, v48, v132
    v_add_f32 v49, v49, v133
    v_lshlrev_b32 v132, 16, v129
    v_and_b32 v133, 0xffff0000, v129
    v_add_f32 v50, v50, v132
    v_add_f32 v51, v51, v133
    v_lshlrev_b32 v132, 16, v130
    v_and_b32 v133, 0xffff0000, v130
    v_add_f32 v48, v48, v132
    v_add_f32 v49, v49, v133
    v_lshlrev_b32 v132, 16, v131
    v_and_b32 v133, 0xffff0000, v131
    v_add_f32 v50, v50, v132
    v_add_f32 v51, v51, v133
    v_cvt_pk_bf16_f32 v72, v48, v49
    v_cvt_pk_bf16_f32 v73, v50, v51
    ds_write_b64 v9, v[72:73] offset:256
    s_mov_b32 s36, 52429
    s_lshl_b32 s16, s12, 5
    s_mul_i32 s16, s16, 1280
    s_mul_i32 s38, s13, 320
    s_add_u32 s16, s16, s38
    s_add_u32 s34, s34, s16
    s_addc_u32 s35, s35, 0
    s_lshl_b32 s19, s14, 6
    v_add_u32 v0, s19, v1
    v_add_u32 v5, 0, v0
    v_mul_lo_u32 v6, v5, s36
    v_lshrrev_b32 v6, 20, v6
    v_mul_u32_u24 v7, 20, v6
    v_sub_u32 v7, v5, v7
    v_mul_u32_u24 v13, 336, v6
    v_lshl_add_u32 v13, v7, 4, v13
    v_add_u32 v13, 57344, v13
    v_mul_u32_u24 v9, 1280, v6
    v_lshl_add_u32 v10, v7, 4, v9
    v_add_u32 v5, 256, v0
    v_mul_lo_u32 v6, v5, s36
    v_lshrrev_b32 v6, 20, v6
    v_mul_u32_u24 v7, 20, v6
    v_sub_u32 v7, v5, v7
    v_mul_u32_u24 v14, 336, v6
    v_lshl_add_u32 v14, v7, 4, v14
    v_add_u32 v14, 57344, v14
    v_mul_u32_u24 v9, 1280, v6
    v_lshl_add_u32 v11, v7, 4, v9
    v_add_u32 v5, 512, v0
    v_mul_lo_u32 v6, v5, s36
    v_lshrrev_b32 v6, 20, v6
    v_mul_u32_u24 v7, 20, v6
    v_sub_u32 v7, v5, v7
    v_mul_u32_u24 v15, 336, v6
    v_lshl_add_u32 v15, v7, 4, v15
    v_add_u32 v15, 57344, v15
    v_mul_u32_u24 v9, 1280, v6
    v_lshl_add_u32 v12, v7, 4, v9
    s_waitcnt lgkmcnt(0)
    s_barrier
    ds_read_b128 v[72:75], v13
    ds_read_b128 v[76:79], v14
    ds_read_b128 v[80:83], v15
    s_waitcnt lgkmcnt(2)
    global_store_dwordx4 v10, v[72:75], s[34:35] sc0 sc1
    s_waitcnt lgkmcnt(1)
    global_store_dwordx4 v11, v[76:79], s[34:35] sc0 sc1
    s_cmp_ge_u32 s14, 2
    s_cbranch_scc1 K2F_SKIP
    s_waitcnt lgkmcnt(0)
    global_store_dwordx4 v12, v[80:83], s[34:35] sc0 sc1
K2F_SKIP:
    s_endpgm
K2_END:
    s_endpgm
K2_TEXT_END:
.section .rodata,"a"
.p2align 6
.amdhsa_kernel k2_kernel
  .amdhsa_next_free_vgpr 168
  .amdhsa_next_free_sgpr 64
  .amdhsa_accum_offset 168
  .amdhsa_group_segment_fixed_size 0
  .amdhsa_kernarg_size 88
  .amdhsa_user_sgpr_count 2
  .amdhsa_user_sgpr_kernarg_segment_ptr 1
  .amdhsa_system_sgpr_workgroup_id_x 1
.end_amdhsa_kernel
```
